```python
import torch

def _softmax(x, axis=-1):
    return torch.softmax(x, dim=axis)
def _gelu(x):
    return torch.nn.functional.gelu(x, approximate="tanh")
def _silu(x):
    return torch.nn.functional.silu(x)
def _sigmoid(x):
    return torch.sigmoid(x)
def _layernorm(x, axis=-1, eps=1e-5):
    m = x.mean(dim=axis, keepdim=True)
    v = x.var(dim=axis, keepdim=True, unbiased=False)
    return (x - m) / torch.sqrt(v + eps)
def _scatter_add(tgt, idx, src, axis=0):
    return tgt.clone().index_add_(axis, idx, src)
def _segment_sum(src, seg, n):
    out = torch.zeros((n,) + src.shape[1:], dtype=src.dtype)
    return out.index_add_(0, seg, src)
def _pad(x, pw):
    flat = tuple(v for pair in reversed(pw) for v in pair)
    return torch.nn.functional.pad(x, flat)

kernel_name = 'parallel_sum__linear_attn_block__mixer_channel_mlp__prompt'

def setup_inputs():

    _w = (lambda a: (lambda t: t.to(torch.bfloat16) if t.is_floating_point() else t)(torch.as_tensor(a)))
    def _A_setup():
        B, S, D = 1, 2048, 448
        return {
            "x": _w((lambda *s: torch.randn(*s, dtype=torch.bfloat16) * 0.05)(B, S, D)),
            "wqkv": _w((lambda *s: torch.randn(*s, dtype=torch.bfloat16) * 0.1)(D, 3 * D)),
            "wo": _w((lambda *s: torch.randn(*s, dtype=torch.bfloat16) * 0.05)(D, D)),
        }
    _A_in = _A_setup()

    def _B_setup():
        B, S, D, F = 1, 2048, 448, 1792
        return {
            "x": _w((lambda *s: torch.randn(*s, dtype=torch.bfloat16) * 0.05)(B, S, D)),
            "w1": _w((lambda *s: torch.randn(*s, dtype=torch.bfloat16) * 1.6)(D, F) * (D ** -0.5)),
            "b1": _w((lambda *s: torch.randn(*s, dtype=torch.bfloat16) * 0.4)(F)),
            "w2": _w((lambda *s: torch.randn(*s, dtype=torch.bfloat16) * 0.05)(F, D) * (F ** -0.5)),
            "b2": _w((lambda *s: torch.randn(*s, dtype=torch.bfloat16) * 0.05)(D)),
        }
    _B_in = _B_setup()

    return {
        "A_x": _A_in["x"],
        "A_wqkv": _A_in["wqkv"],
        "A_wo": _A_in["wo"],
        "B_x": _B_in["x"],
        "B_w1": _B_in["w1"],
        "B_b1": _B_in["b1"],
        "B_w2": _B_in["w2"],
        "B_b2": _B_in["b2"],
    }

def reference(A_x, A_wqkv, A_wo, B_x, B_w1, B_b1, B_w2, B_b2):
    def _A_ref(x, wqkv, wo):
        B, S, D = x.shape
        H = 16; Dh = D // H
        qkv = (lambda x, *d: x.permute(*d))((x @ wqkv).reshape(B, S, 3, H, Dh), 2, 0, 3, 1, 4)
        q, k, v = qkv[0], qkv[1], qkv[2]
        phi = lambda t: torch.where(t > 0, t + 1, torch.exp(t)) + 1e-6
        pq, pk = phi(q), phi(k)
        kv = torch.einsum("bhsd,bhse->bhde", pk, v)
        z = torch.einsum("bhsd->bhd", pk)
        num = torch.einsum("bhqd,bhde->bhqe", pq, kv)
        den = torch.einsum("bhqd,bhd->bhq", pq, z)[..., None] + 1e-6
        o = num / den
        return (lambda x, *d: x.permute(*d))(o, 0, 2, 1, 3).reshape(B, S, D) @ wo

    def _B_ref(x, w1, b1, w2, b2):
        y = _layernorm(x, axis=-1)
        h = _gelu(torch.einsum("bsd,df->bsf", y, w1) + b1)
        return torch.einsum("bsf,fd->bsd", h, w2) + b2

    x = A_x
    xn = _layernorm(x, axis=-1)
    return x + _A_ref(xn, A_wqkv, A_wo) + _B_ref(xn, B_w1, B_b1, B_w2, B_b2)
```

```asm
; @launch grid=(256,1,1) block=(512,1,1) lds=163840
.amdgcn_target "amdgcn-amd-amdhsa--gfx950"
.text
.globl parallel_sum__linear_attn_block__mixer_channel_mlp__prompt_kernel
.p2align 8
.type parallel_sum__linear_attn_block__mixer_channel_mlp__prompt_kernel,@function
parallel_sum__linear_attn_block__mixer_channel_mlp__prompt_kernel:
    s_load_dwordx16 s[4:19], s[0:1], 0
    s_load_dwordx4 s[20:23], s[0:1], 64
    s_load_dwordx2 s[24:25], s[0:1], 80
    s_cmp_ge_u32 s2, 256
    s_cbranch_scc1 Lend
    s_setprio 1
    v_lshrrev_b32 v1, 6, v0
    v_and_b32 v0, 63, v0
    v_readfirstlane_b32 s3, v1
    s_and_b32 s26, s2, 7
    s_lshr_b32 s31, s2, 3
    s_and_b32 s27, s31, 3
    s_lshr_b32 s28, s31, 2
    s_cmp_lg_u32 s3, 7
    s_cbranch_scc1 Lnopf
    s_getpc_b64 s[76:77]
Lpc:
    s_and_b32 s31, s31, 7
    s_lshl_b32 s31, s31, 13
    v_lshl_add_u32 v4, v0, 7, s31
    v_min_u32 v4, Lcode_end-Lpc-4, v4
    global_load_dword v24, v4, s[76:77]
Lnopf:
    s_lshr_b32 s31, s26, 1
    s_lshl_b32 s31, s31, 2
    s_add_u32 s29, s31, s27
    s_lshl_b32 s31, s28, 1
    s_add_u32 s31, s31, s29
    s_mul_i32 s32, s31, 37
    s_lshr_b32 s32, s32, 8
    s_mul_i32 s32, s32, 7
    s_sub_u32 s30, s31, s32
    s_mov_b32 s75, s30
    s_lshl_b32 s31, s29, 7
    s_lshl_b32 s32, s3, 4
    s_add_u32 s31, s31, s32
    v_lshrrev_b32 v4, 3, v0
    v_add_u32 v4, s31, v4
    v_mul_u32_u24 v4, 896, v4
    v_and_b32 v5, 7, v0
    v_lshrrev_b32 v6, 4, v0
    v_xor_b32 v6, v5, v6
    v_lshl_add_u32 v8, v6, 4, v4
    v_xor_b32 v6, 4, v6
    v_lshl_add_u32 v9, v6, 4, v4
    v_add_u32 v9, 7168, v9
    s_lshl_b32 s71, s3, 11
    s_mov_b32 s38, 1835008
    s_mov_b32 s39, 0x20000
    s_lshl_b32 s99, s2, 3
    s_add_u32 s99, s99, s3
    s_mul_i32 s32, s99, 896
    v_lshlrev_b32 v1, 4, v0
    v_add_u32 v7, s32, v1
    v_mov_b32 v5, 117440512
    v_cmp_gt_u32 vcc, 56, v0
    s_nop 1
    v_cndmask_b32 v7, v5, v7, vcc
    v_cndmask_b32 v225, 0, 1.0, vcc
    s_cmp_lt_u32 s28, 6
    s_cbranch_scc1 Lm
    s_and_b32 s31, s26, 1
    s_mul_i32 s32, s31, 3
    s_add_u32 s34, s31, 1
    s_cmp_eq_u32 s28, 6
    s_cselect_b32 s92, s32, s34
    s_mul_i32 s31, s92, 224
    s_cmp_eq_u32 s92, 3
    s_cselect_b32 s31, 640, s31
    s_add_u32 s31, s31, 896
    v_lshrrev_b32 v4, 4, v0
    v_lshlrev_b32 v5, 2, v4
    v_sub_u32 v5, v0, v5
    v_and_b32 v5, 15, v5
    v_lshl_add_u32 v5, v5, 4, s31
    v_lshl_add_u32 v4, s3, 3, v4
    v_mul_u32_u24 v4, 2688, v4
    v_add_u32 v10, v4, v5
    v_add_u32 v11, 10752, v10
    s_lshl_b32 s72, s3, 11
    s_add_u32 s72, s72, 16384
    s_waitcnt lgkmcnt(0)
    s_load_dword s94, s[24:25], 0
    s_mov_b32 s36, s4
    s_and_b32 s37, s5, 0xffff
    buffer_load_dwordx4 v[208:211], v7, s[36:39], 0 offen
    s_mov_b32 s40, s6
    s_and_b32 s41, s7, 0xffff
    s_mov_b32 s42, 1204224
    s_mov_b32 s43, 0x20000
    s_add_u32 m0, s71, 0
    s_lshl_b32 s64, s30, 7
    buffer_load_dwordx4 v8, s[36:39], s64 offen lds
    s_add_u32 m0, s71, 1024
    s_mul_i32 s65, s30, 172032
    buffer_load_dwordx4 v9, s[36:39], s64 offen lds
    s_add_u32 m0, s72, 0
    s_add_u32 s66, s65, 896
    buffer_load_dwordx4 v10, s[40:43], s65 offen lds
    s_add_u32 m0, s72, 1024
    s_nop 0
    buffer_load_dwordx4 v11, s[40:43], s65 offen lds
    s_add_u32 m0, s72, 16384
    s_nop 0
    buffer_load_dwordx4 v10, s[40:43], s66 offen lds
    s_add_u32 m0, s72, 17408
    s_add_u32 s30, s30, 1
    buffer_load_dwordx4 v11, s[40:43], s66 offen lds
    s_cmp_eq_u32 s30, 7
    s_cselect_b32 s30, 0, s30
    s_branch Lkv2
Lm:
    s_and_b32 s31, s26, 1
    s_mul_i32 s31, s31, 6
    s_add_u32 s92, s31, s28
    v_lshrrev_b32 v4, 3, v0
    v_lshl_add_u32 v4, s3, 3, v4
    v_bfe_u32 v5, v0, 4, 1
    v_lshlrev_b32 v5, 2, v5
    v_and_b32 v6, 7, v0
    v_xor_b32 v5, v5, v6
    v_lshlrev_b32 v5, 4, v5
    s_lshl_b32 s72, s3, 10
    s_mul_i32 s34, s92, 3
    s_add_u32 s31, s34, 0
    s_sub_u32 s32, s31, 28
    s_cmp_lt_u32 s31, 35
    s_cselect_b32 s42, 1204224, 0
    s_cmp_lt_u32 s31, 28
    s_cselect_b32 s42, 1605632, s42
    s_cselect_b32 s31, s31, s32
    s_movk_i32 s32, 2688
    s_cselect_b32 s32, 3584, s32
    s_lshl_b32 s31, s31, 7
    s_lshl_b32 s68, s32, 6
    v_mad_u32_u24 v10, v4, s32, v5
    v_add_u32 v10, s31, v10
    s_mov_b32 s43, 0x20000
    s_add_u32 s31, s34, 1
    s_sub_u32 s32, s31, 28
    s_cmp_lt_u32 s31, 35
    s_cselect_b32 s46, 1204224, 0
    s_cmp_lt_u32 s31, 28
    s_cselect_b32 s46, 1605632, s46
    s_cselect_b32 s31, s31, s32
    s_movk_i32 s32, 2688
    s_cselect_b32 s32, 3584, s32
    s_lshl_b32 s31, s31, 7
    s_lshl_b32 s69, s32, 6
    v_mad_u32_u24 v11, v4, s32, v5
    v_add_u32 v11, s31, v11
    s_mov_b32 s47, 0x20000
    s_add_u32 s31, s34, 2
    s_sub_u32 s32, s31, 28
    s_cmp_lt_u32 s31, 35
    s_cselect_b32 s50, 1204224, 0
    s_cmp_lt_u32 s31, 28
    s_cselect_b32 s50, 1605632, s50
    s_cselect_b32 s31, s31, s32
    s_movk_i32 s32, 2688
    s_cselect_b32 s32, 3584, s32
    s_lshl_b32 s31, s31, 7
    s_lshl_b32 s70, s32, 6
    v_mad_u32_u24 v12, v4, s32, v5
    v_add_u32 v12, s31, v12
    s_mov_b32 s51, 0x20000
    s_mul_i32 s67, s30, s70
    s_waitcnt lgkmcnt(0)
    s_load_dword s94, s[24:25], 0
    s_mov_b32 s36, s4
    s_and_b32 s37, s5, 0xffff
    buffer_load_dwordx4 v[208:211], v7, s[36:39], 0 offen
    s_and_b32 s13, s13, 0xffff
    s_and_b32 s7, s7, 0xffff
    s_cmp_eq_u32 s68, 229376
    s_cselect_b32 s40, s12, s6
    s_cselect_b32 s41, s13, s7
    s_cmp_eq_u32 s69, 229376
    s_cselect_b32 s44, s12, s6
    s_cselect_b32 s45, s13, s7
    s_cmp_eq_u32 s70, 229376
    s_cselect_b32 s48, s12, s6
    s_cselect_b32 s49, s13, s7
    s_add_u32 m0, s71, 114688
    s_lshl_b32 s64, s30, 7
    buffer_load_dwordx4 v8, s[36:39], s64 offen lds
    s_add_u32 m0, s71, 115712
    s_mul_i32 s65, s30, s68
    buffer_load_dwordx4 v9, s[36:39], s64 offen lds
    s_add_u32 m0, s72, 131072
    s_mul_i32 s66, s30, s69
    buffer_load_dwordx4 v10, s[40:43], s65 offen lds
    s_add_u32 m0, s72, 139264
    s_add_u32 s30, s30, 1
    buffer_load_dwordx4 v11, s[44:47], s66 offen lds
    s_cmp_eq_u32 s30, 7
    s_cselect_b32 s30, 0, s30
    s_and_b32 s73, s3, 3
    s_lshr_b32 s74, s3, 2
    s_lshl_b32 s34, s73, 12
    v_lshrrev_b32 v4, 2, v0
    v_lshrrev_b32 v5, 4, v0
    v_xor_b32 v4, v4, v5
    v_and_b32 v4, 1, v4
    v_and_b32 v5, 3, v0
    v_or_b32 v4, v4, v5
    v_cmp_eq_u32 vcc, 0, v4
    v_mov_b32 v5, 0x3f803f80
    v_and_b32 v4, 31, v0
    v_cndmask_b32 v28, 0, v5, vcc
    v_cndmask_b32 v29, 0, v5, vcc
    v_cndmask_b32 v30, 0, v5, vcc
    v_cndmask_b32 v31, 0, v5, vcc
    s_add_u32 s34, s34, 65536
    v_lshl_add_u32 v5, v4, 7, s34
    v_bfe_u32 v4, v0, 1, 3
    v_lshrrev_b32 v6, 5, v0
    v_xor_b32 v4, v4, v6
    v_lshl_add_u32 v13, v4, 4, v5
    v_xor_b32 v14, 32, v13
    v_xor_b32 v15, 64, v13
    v_xor_b32 v16, 96, v13
    s_lshl_b32 s31, s99, 4
    s_add_u32 s31, s31, 65536
    v_mov_b32 v5, 117440512
    v_mov_b32 v6, s31
    v_cmp_eq_u32 vcc, 63, v0
    s_nop 1
    v_cndmask_b32 v226, v5, v6, vcc
    s_mov_b32 s52, s24
    s_and_b32 s53, s25, 0xffff
    s_mov_b32 s54, 12582912
    s_mov_b32 s55, 0x20000
    v_lshrrev_b32 v4, 5, v0
    v_lshlrev_b32 v4, 3, v4
    v_bfe_u32 v5, v0, 2, 2
    v_add_u32 v4, v4, v5
    v_lshlrev_b32 v4, 7, v4
    v_bfe_u32 v5, v0, 4, 1
    v_lshl_add_u32 v4, v5, 5, v4
    v_and_b32 v5, 3, v0
    v_lshl_add_u32 v4, v5, 3, v4
    v_bfe_u32 v5, v0, 3, 1
    v_lshl_add_u32 v4, v5, 6, v4
    s_lshl_b32 s31, s74, 6
    v_xor_b32 v17, s31, v4
    v_add_u32 v18, 65536, v17
    v_add_u32 v19, 131072, v17
    s_add_u32 m0, s72, 147456
    s_nop 0
    buffer_load_dwordx4 v12, s[48:51], s67 offen lds
    s_add_u32 s67, s67, s70
    s_cmp_eq_u32 s67, s50
    s_cselect_b32 s67, 0, s67
    s_add_u32 m0, s71, 65536
    s_lshl_b32 s64, s30, 7
    buffer_load_dwordx4 v8, s[36:39], s64 offen lds
    s_add_u32 m0, s71, 66560
    s_mul_i32 s65, s30, s68
    buffer_load_dwordx4 v9, s[36:39], s64 offen lds
    s_add_u32 m0, s72, 49152
    s_mul_i32 s66, s30, s69
    buffer_load_dwordx4 v10, s[40:43], s65 offen lds
    s_add_u32 m0, s72, 57344
    s_add_u32 s30, s30, 1
    buffer_load_dwordx4 v11, s[44:47], s66 offen lds
    s_cmp_eq_u32 s30, 7
    s_cselect_b32 s30, 0, s30
    s_cmp_lg_u32 s3, 6
    s_cbranch_scc1 Lpf_1
    s_mul_i32 s31, s2, 6272
    v_min_u32 v4, 48, v0
    v_lshl_add_u32 v4, v4, 7, s31
    global_load_dword v24, v4, s[16:17]
Lpf_1:
    s_cmp_lg_u32 s3, 5
    s_cbranch_scc1 Lpf_2
    s_mul_i32 s31, s2, 1664
    v_min_u32 v4, 12, v0
    v_lshl_add_u32 v4, v4, 7, s31
    v_min_u32 v4, 401404, v4
    global_load_dword v24, v4, s[8:9]
    v_min_u32 v4, 6, v0
    v_lshlrev_b32 v4, 7, v4
    global_load_dword v24, v4, s[18:19]
Lpf_2:
    s_cmp_lg_u32 s3, 4
    s_cbranch_scc1 Lpf_3
    s_lshr_b32 s31, s2, 3
    s_mul_i32 s31, s31, 50176
    s_add_u32 s31, s31, 768
    v_min_u32 v4, 55, v0
    v_mul_u32_u24 v4, 896, v4
    v_add_u32 v4, s31, v4
    global_load_dword v24, v4, s[16:17]
Lpf_3:
    s_waitcnt vmcnt(9)
    v_lshlrev_b32 v212, 16, v208
    v_and_b32 v213, 0xffff0000, v208
    v_lshlrev_b32 v214, 16, v209
    v_and_b32 v215, 0xffff0000, v209
    v_lshlrev_b32 v216, 16, v210
    v_and_b32 v217, 0xffff0000, v210
    v_lshlrev_b32 v218, 16, v211
    v_and_b32 v219, 0xffff0000, v211
    v_pk_add_f32 v[208:209], v[212:213], v[214:215]
    v_pk_add_f32 v[210:211], v[216:217], v[218:219]
    v_pk_add_f32 v[208:209], v[208:209], v[210:211]
    v_add_f32 v224, v208, v209
    s_nop 1
    v_add_f32_dpp v224, v224, v224 quad_perm:[1,0,3,2] row_mask:0xf bank_mask:0xf
    s_nop 1
    v_add_f32_dpp v224, v224, v224 quad_perm:[2,3,0,1] row_mask:0xf bank_mask:0xf
    s_nop 1
    v_add_f32_dpp v224, v224, v224 row_half_mirror row_mask:0xf bank_mask:0xf
    s_nop 1
    v_add_f32_dpp v224, v224, v224 row_mirror row_mask:0xf bank_mask:0xf
    s_nop 1
    v_add_f32_dpp v224, v224, v224 row_bcast:15 row_mask:0xa bank_mask:0xf
    s_nop 1
    v_add_f32_dpp v224, v224, v224 row_bcast:31 row_mask:0xc bank_mask:0xf
    v_mul_f32 v220, 0x3b124925, v224
    s_nop 0
    v_readlane_b32 s99, v220, 63
    s_nop 1
    v_mul_f32 v224, s99, v225
    v_pk_add_f32 v[212:213], v[212:213], v[224:225] op_sel_hi:[1,0] neg_lo:[0,1] neg_hi:[0,1]
    v_pk_add_f32 v[214:215], v[214:215], v[224:225] op_sel_hi:[1,0] neg_lo:[0,1] neg_hi:[0,1]
    v_pk_add_f32 v[216:217], v[216:217], v[224:225] op_sel_hi:[1,0] neg_lo:[0,1] neg_hi:[0,1]
    v_pk_add_f32 v[218:219], v[218:219], v[224:225] op_sel_hi:[1,0] neg_lo:[0,1] neg_hi:[0,1]
    v_pk_mul_f32 v[208:209], v[212:213], v[212:213]
    v_pk_fma_f32 v[208:209], v[214:215], v[214:215], v[208:209]
    v_pk_fma_f32 v[208:209], v[216:217], v[216:217], v[208:209]
    v_pk_fma_f32 v[208:209], v[218:219], v[218:219], v[208:209]
    v_add_f32 v224, v208, v209
    s_nop 1
    v_add_f32_dpp v224, v224, v224 quad_perm:[1,0,3,2] row_mask:0xf bank_mask:0xf
    s_nop 1
    v_add_f32_dpp v224, v224, v224 quad_perm:[2,3,0,1] row_mask:0xf bank_mask:0xf
    s_nop 1
    v_add_f32_dpp v224, v224, v224 row_half_mirror row_mask:0xf bank_mask:0xf
    s_nop 1
    v_add_f32_dpp v224, v224, v224 row_mirror row_mask:0xf bank_mask:0xf
    s_nop 1
    v_add_f32_dpp v224, v224, v224 row_bcast:15 row_mask:0xa bank_mask:0xf
    s_nop 1
    v_add_f32_dpp v224, v224, v224 row_bcast:31 row_mask:0xc bank_mask:0xf
    v_mul_f32 v222, 0x3b124925, v224
    s_waitcnt lgkmcnt(0)
    s_mul_i32 s94, s94, 1664525
    s_add_u32 s94, s94, 1013904223
    v_mov_b32 v248, s94
    v_mov_b32 v221, s94
    v_mov_b32 v223, s94
    buffer_store_dwordx4 v[220:223], v226, s[52:55], 0 offen sc1
    s_waitcnt vmcnt(6)
    s_barrier
    ds_read_b128 v[96:99], v13 offset:49152
    ds_read_b64_tr_b16 v[32:33], v19 offset:0
    ds_read_b64_tr_b16 v[34:35], v19 offset:512
    ds_read_b64_tr_b16 v[36:37], v19 offset:8192
    ds_read_b64_tr_b16 v[38:39], v19 offset:8704
    ds_read_b128 v[100:103], v14 offset:49152
    ds_read_b64_tr_b16 v[40:41], v19 offset:2048
    ds_read_b64_tr_b16 v[42:43], v19 offset:2560
    ds_read_b64_tr_b16 v[44:45], v19 offset:10240
    ds_read_b64_tr_b16 v[46:47], v19 offset:10752
    s_waitcnt lgkmcnt(5)
    v_mfma_f32_32x32x16_bf16 v[64:79], v[32:35], v[96:99], 0
    ds_read_b128 v[104:107], v15 offset:49152
    ds_read_b64_tr_b16 v[240:241], v19 offset:4096
    ds_read_b64_tr_b16 v[242:243], v19 offset:4608
    ds_read_b64_tr_b16 v[244:245], v19 offset:12288
    ds_read_b64_tr_b16 v[246:247], v19 offset:12800
    v_mfma_f32_32x32x16_bf16 v[80:95], v[36:39], v[96:99], 0
    s_add_u32 m0, s71, 81920
    s_lshl_b32 s64, s30, 7
    buffer_load_dwordx4 v8, s[36:39], s64 offen lds
    v_mfma_f32_16x16x32_bf16 v[48:51], v[28:31], v[32:35], 0
    v_mov_b32 v5, 117440512
    v_lshlrev_b32 v4, 2, v0
    v_mfma_f32_16x16x32_bf16 v[52:55], v[28:31], v[36:39], 0
    s_add_u32 m0, s71, 82944
    s_mul_i32 s65, s30, s68
    buffer_load_dwordx4 v9, s[36:39], s64 offen lds
    v_cmp_gt_u32 vcc, 32, v0
    s_nop 1
    v_cndmask_b32 v249, v5, v4, vcc
    s_waitcnt lgkmcnt(5)
    v_mfma_f32_32x32x16_bf16 v[64:79], v[40:43], v[100:103], v[64:79]
    ds_read_b128 v[108:111], v16 offset:49152
    ds_read_b64_tr_b16 v[32:33], v19 offset:6144
    ds_read_b64_tr_b16 v[34:35], v19 offset:6656
    ds_read_b64_tr_b16 v[36:37], v19 offset:14336
    ds_read_b64_tr_b16 v[38:39], v19 offset:14848
    v_mfma_f32_32x32x16_bf16 v[80:95], v[44:47], v[100:103], v[80:95]
    s_add_u32 m0, s72, 98304
    s_mul_i32 s66, s30, s69
    buffer_load_dwordx4 v10, s[40:43], s65 offen lds
    v_mfma_f32_16x16x32_bf16 v[48:51], v[28:31], v[40:43], v[48:51]
    s_mov_b32 s78, 0
    s_mov_b32 s79, -1
    v_mfma_f32_16x16x32_bf16 v[52:55], v[28:31], v[44:47], v[52:55]
    s_add_u32 m0, s72, 106496
    s_add_u32 s30, s30, 1
    buffer_load_dwordx4 v11, s[44:47], s66 offen lds
    s_cmp_eq_u32 s30, 7
    s_cselect_b32 s30, 0, s30
    s_mov_b32 s88, 0x358637bd
    s_mov_b32 s89, 0x358637bd
    s_waitcnt lgkmcnt(0)
    s_waitcnt vmcnt(5)
    s_barrier
    v_mfma_f32_32x32x16_bf16 v[64:79], v[240:243], v[104:107], v[64:79]
    ds_read_b128 v[112:115], v13 offset:0
    ds_read_b64_tr_b16 v[40:41], v17 offset:49152
    ds_read_b64_tr_b16 v[42:43], v17 offset:49664
    ds_read_b64_tr_b16 v[44:45], v17 offset:57344
    ds_read_b64_tr_b16 v[46:47], v17 offset:57856
    ds_read_b64_tr_b16 v[60:61], v19 offset:16384
    ds_read_b64_tr_b16 v[62:63], v19 offset:16896
    v_mfma_f32_32x32x16_bf16 v[80:95], v[244:247], v[104:107], v[80:95]
    s_add_u32 m0, s71, 114688
    s_lshl_b32 s64, s30, 7
    buffer_load_dwordx4 v8, s[36:39], s64 offen lds
    v_mfma_f32_16x16x32_bf16 v[48:51], v[28:31], v[240:243], v[48:51]
    s_mov_b32 s95, s28
    s_lshl_b32 s96, s26, 2
    v_mfma_f32_16x16x32_bf16 v[52:55], v[28:31], v[244:247], v[52:55]
    s_add_u32 s96, s96, s27
    s_lshl_b32 s35, s92, 1
    v_mfma_f32_32x32x16_bf16 v[64:79], v[32:35], v[108:111], v[64:79]
    ds_read_b128 v[116:119], v14 offset:0
    ds_read_b64_tr_b16 v[240:241], v17 offset:51200
    ds_read_b64_tr_b16 v[242:243], v17 offset:51712
    ds_read_b64_tr_b16 v[244:245], v17 offset:59392
    ds_read_b64_tr_b16 v[246:247], v17 offset:59904
    ds_read_b64_tr_b16 v[228:229], v19 offset:18432
    ds_read_b64_tr_b16 v[230:231], v19 offset:18944
    v_mfma_f32_32x32x16_bf16 v[80:95], v[36:39], v[108:111], v[80:95]
    s_add_u32 m0, s71, 115712
    s_mul_i32 s65, s30, s68
    buffer_load_dwordx4 v9, s[36:39], s64 offen lds
    v_mfma_f32_16x16x32_bf16 v[48:51], v[28:31], v[32:35], v[48:51]
    s_add_u32 s35, s35, s74
    s_mul_i32 s97, s92, 6
    v_mfma_f32_16x16x32_bf16 v[52:55], v[28:31], v[36:39], v[52:55]
    s_add_u32 s97, s97, s74
    s_lshl_b32 s31, s35, 12
    s_waitcnt lgkmcnt(9)
    v_mfma_f32_32x32x16_bf16 v[64:79], v[40:43], v[112:115], v[64:79]
    ds_read_b128 v[120:123], v15 offset:0
    ds_read_b64_tr_b16 v[32:33], v17 offset:53248
    ds_read_b64_tr_b16 v[34:35], v17 offset:53760
    ds_read_b64_tr_b16 v[36:37], v17 offset:61440
    ds_read_b64_tr_b16 v[38:39], v17 offset:61952
    ds_read_b64_tr_b16 v[232:233], v19 offset:20480
    ds_read_b64_tr_b16 v[234:235], v19 offset:20992
    v_mfma_f32_32x32x16_bf16 v[80:95], v[44:47], v[112:115], v[80:95]
    s_add_u32 m0, s72, 131072
    s_mul_i32 s66, s30, s69
    buffer_load_dwordx4 v10, s[40:43], s65 offen lds
    s_add_u32 s31, s31, 98304
    v_add_u32 v21, s31, v1
    s_waitcnt lgkmcnt(14)
    v_mfma_f32_16x16x32_bf16 v[56:59], v[28:31], v[60:63], 0
    s_add_u32 m0, s72, 139264
    s_add_u32 s30, s30, 1
    buffer_load_dwordx4 v11, s[44:47], s66 offen lds
    s_cmp_eq_u32 s30, 7
    s_cselect_b32 s30, 0, s30
    s_lshl_b32 s32, s75, 9
    v_add_u32 v4, s32, v21
    s_waitcnt lgkmcnt(9)
    v_mfma_f32_32x32x16_bf16 v[64:79], v[240:243], v[116:119], v[64:79]
    ds_read_b128 v[124:127], v16 offset:0
    ds_read_b64_tr_b16 v[40:41], v17 offset:55296
    ds_read_b64_tr_b16 v[42:43], v17 offset:55808
    ds_read_b64_tr_b16 v[44:45], v17 offset:63488
    ds_read_b64_tr_b16 v[46:47], v17 offset:64000
    ds_read_b64_tr_b16 v[236:237], v19 offset:22528
    ds_read_b64_tr_b16 v[238:239], v19 offset:23040
    v_mfma_f32_32x32x16_bf16 v[80:95], v[244:247], v[116:119], v[80:95]
    v_mov_b32 v5, 117440512
    v_cndmask_b32 v4, v4, v5, s[78:79]
    s_waitcnt lgkmcnt(14)
    v_mfma_f32_16x16x32_bf16 v[56:59], v[28:31], v[228:231], v[56:59]
    s_cmp_lt_u32 s29, 7
    s_cselect_b32 s32, s73, 1
    s_waitcnt lgkmcnt(0)
    s_waitcnt vmcnt(4)
    s_barrier
    v_mfma_f32_32x32x16_bf16 v[64:79], v[32:35], v[120:123], v[64:79]
    ds_read_b128 v[128:131], v13 offset:16384
    ds_read_b64_tr_b16 v[240:241], v18 offset:32768
    ds_read_b64_tr_b16 v[242:243], v18 offset:33280
    ds_read_b64_tr_b16 v[244:245], v18 offset:40960
    ds_read_b64_tr_b16 v[246:247], v18 offset:41472
    v_mfma_f32_32x32x16_bf16 v[80:95], v[36:39], v[120:123], v[80:95]
    s_add_u32 m0, s71, 65536
    s_lshl_b32 s64, s30, 7
    buffer_load_dwordx4 v8, s[36:39], s64 offen lds
    v_mfma_f32_16x16x32_bf16 v[56:59], v[28:31], v[232:235], v[56:59]
    s_cmp_eq_u32 s32, 0
    s_cselect_b32 s32, 0, 117440512
    v_add_u32 v22, s32, v4
    s_mov_b32 s60, s14
    v_mfma_f32_32x32x16_bf16 v[64:79], v[40:43], v[124:127], v[64:79]
    ds_read_b128 v[132:135], v14 offset:16384
    ds_read_b64_tr_b16 v[32:33], v18 offset:34816
    ds_read_b64_tr_b16 v[34:35], v18 offset:35328
    ds_read_b64_tr_b16 v[36:37], v18 offset:43008
    ds_read_b64_tr_b16 v[38:39], v18 offset:43520
    v_mfma_f32_32x32x16_bf16 v[80:95], v[44:47], v[124:127], v[80:95]
    s_add_u32 m0, s71, 66560
    s_mul_i32 s65, s30, s68
    buffer_load_dwordx4 v9, s[36:39], s64 offen lds
    s_and_b32 s61, s15, 0xffff
    s_mov_b32 s62, 3584
    v_mfma_f32_16x16x32_bf16 v[56:59], v[28:31], v[236:239], v[56:59]
    s_mov_b32 s63, 0x20000
    s_lshl_b32 s31, s97, 6
    v_and_b32 v4, 31, v0
    v_lshl_add_u32 v27, v4, 1, s31
    s_waitcnt lgkmcnt(5)
    v_mfma_f32_32x32x16_bf16 v[64:79], v[240:243], v[128:131], v[64:79]
    ds_read_b128 v[136:139], v15 offset:16384
    ds_read_b64_tr_b16 v[40:41], v18 offset:36864
    ds_read_b64_tr_b16 v[42:43], v18 offset:37376
    ds_read_b64_tr_b16 v[44:45], v18 offset:45056
    ds_read_b64_tr_b16 v[46:47], v18 offset:45568
    v_mfma_f32_32x32x16_bf16 v[80:95], v[244:247], v[128:131], v[80:95]
    s_add_u32 m0, s72, 49152
    s_mul_i32 s66, s30, s69
    buffer_load_dwordx4 v10, s[40:43], s65 offen lds
    s_add_u32 m0, s72, 57344
    s_add_u32 s30, s30, 1
    buffer_load_dwordx4 v11, s[44:47], s66 offen lds
    s_cmp_eq_u32 s30, 7
    s_cselect_b32 s30, 0, s30
    s_waitcnt lgkmcnt(5)
    v_mfma_f32_32x32x16_bf16 v[64:79], v[32:35], v[132:135], v[64:79]
    ds_read_b128 v[140:143], v16 offset:16384
    ds_read_b64_tr_b16 v[240:241], v18 offset:38912
    ds_read_b64_tr_b16 v[242:243], v18 offset:39424
    ds_read_b64_tr_b16 v[244:245], v18 offset:47104
    ds_read_b64_tr_b16 v[246:247], v18 offset:47616
    v_mfma_f32_32x32x16_bf16 v[80:95], v[36:39], v[132:135], v[80:95]
    v_mov_b32 v212, v48
    v_mov_b32 v213, v52
    v_mov_b32 v214, v56
    v_mov_b32 v215, v248
    buffer_store_dwordx4 v[212:215], v22, s[52:55], 0 offen sc1
    buffer_load_ushort v25, v27, s[60:63], 0 offen offset:0
    buffer_load_ushort v26, v27, s[60:63], 0 offen offset:128
    buffer_load_ushort v27, v27, s[60:63], 0 offen offset:256
    s_waitcnt lgkmcnt(0)
    s_waitcnt vmcnt(8)
    s_barrier
    v_mfma_f32_32x32x16_bf16 v[64:79], v[40:43], v[136:139], v[64:79]
    ds_read_b128 v[144:147], v13 offset:49152
    ds_read_b64_tr_b16 v[32:33], v19 offset:0
    ds_read_b64_tr_b16 v[34:35], v19 offset:512
    ds_read_b64_tr_b16 v[36:37], v19 offset:8192
    ds_read_b64_tr_b16 v[38:39], v19 offset:8704
    v_mfma_f32_32x32x16_bf16 v[80:95], v[44:47], v[136:139], v[80:95]
    s_add_u32 m0, s71, 81920
    s_lshl_b32 s64, s30, 7
    buffer_load_dwordx4 v8, s[36:39], s64 offen lds
    s_lshl_b32 s31, s29, 2
    s_add_u32 s31, s31, s73
    s_lshl_b32 s32, s31, 9
    s_add_u32 s32, s32, 65536
    v_and_b32 v4, 31, v0
    v_lshl_add_u32 v250, v4, 4, s32
    v_mfma_f32_32x32x16_bf16 v[64:79], v[240:243], v[140:143], v[64:79]
    ds_read_b128 v[148:151], v14 offset:49152
    ds_read_b64_tr_b16 v[40:41], v19 offset:2048
    ds_read_b64_tr_b16 v[42:43], v19 offset:2560
    ds_read_b64_tr_b16 v[44:45], v19 offset:10240
    ds_read_b64_tr_b16 v[46:47], v19 offset:10752
    v_mfma_f32_32x32x16_bf16 v[80:95], v[244:247], v[140:143], v[80:95]
    s_add_u32 m0, s71, 82944
    s_mul_i32 s65, s30, s68
    buffer_load_dwordx4 v9, s[36:39], s64 offen lds
    s_lshl_b32 s11, s31, 13
    s_mul_i32 s31, s31, 143360
    s_lshl_b32 s32, s97, 11
    s_add_u32 s10, s31, s32
    s_add_u32 s10, s10, 2097152
    s_lshl_b32 s32, s35, 7
    s_add_u32 s11, s11, s32
    s_add_u32 s11, s11, 11534336
    s_waitcnt lgkmcnt(5)
    v_mfma_f32_32x32x16_bf16 v[64:79], v[32:35], v[144:147], v[64:79]
    ds_read_b128 v[152:155], v15 offset:49152
    ds_read_b64_tr_b16 v[240:241], v19 offset:4096
    ds_read_b64_tr_b16 v[242:243], v19 offset:4608
    ds_read_b64_tr_b16 v[244:245], v19 offset:12288
    ds_read_b64_tr_b16 v[246:247], v19 offset:12800
    v_mfma_f32_32x32x16_bf16 v[80:95], v[36:39], v[144:147], v[80:95]
    s_add_u32 m0, s72, 98304
    s_mul_i32 s66, s30, s69
    buffer_load_dwordx4 v10, s[40:43], s65 offen lds
    s_and_b32 s31, s95, 0
    s_lshl_b32 s31, s31, 2
    s_add_u32 m0, s72, 106496
    s_add_u32 s30, s30, 1
    buffer_load_dwordx4 v11, s[44:47], s66 offen lds
    s_cmp_eq_u32 s30, 7
    s_cselect_b32 s30, 0, s30
    s_xor_b32 s87, s3, s31
    s_mov_b32 s80, 0x3010200
    s_add_u32 m0, s72, 0
    s_nop 0
    buffer_load_dwordx4 v12, s[48:51], s67 offen lds
    s_add_u32 s67, s67, s70
    s_cmp_eq_u32 s67, s50
    s_cselect_b32 s67, 0, s67
    s_mov_b32 s81, 0x313230
    s_cmp_eq_u32 s87, 1
    s_cselect_b32 s80, 0x9070806, s80
    s_cselect_b32 s81, 0x373633, s81
    s_waitcnt lgkmcnt(5)
    v_mfma_f32_32x32x16_bf16 v[64:79], v[40:43], v[148:151], v[64:79]
    ds_read_b128 v[156:159], v16 offset:49152
    ds_read_b64_tr_b16 v[32:33], v19 offset:6144
    ds_read_b64_tr_b16 v[34:35], v19 offset:6656
    ds_read_b64_tr_b16 v[36:37], v19 offset:14336
    ds_read_b64_tr_b16 v[38:39], v19 offset:14848
    v_mfma_f32_32x32x16_bf16 v[80:95], v[44:47], v[148:151], v[80:95]
    s_cmp_eq_u32 s87, 2
    s_cselect_b32 s80, 0xf0d0e0c, s80
    s_cselect_b32 s81, 0xa0504, s81
    s_cmp_eq_u32 s87, 3
    s_cselect_b32 s80, 0x15131412, s80
    s_cselect_b32 s81, 0x11100b, s81
    s_cmp_eq_u32 s87, 4
    s_cselect_b32 s80, 0x1b191a18, s80
    s_cselect_b32 s81, 0x1c1716, s81
    s_cmp_eq_u32 s87, 5
    s_cselect_b32 s80, 0x211f201e, s80
    s_cselect_b32 s81, 0x23221d, s81
    s_waitcnt lgkmcnt(0)
    s_waitcnt vmcnt(9)
    s_barrier
    v_mfma_f32_32x32x16_bf16 v[64:79], v[240:243], v[152:155], v[64:79]
    ds_read_b128 v[160:163], v13 offset:0
    ds_read_b64_tr_b16 v[40:41], v17 offset:49152
    ds_read_b64_tr_b16 v[42:43], v17 offset:49664
    ds_read_b64_tr_b16 v[44:45], v17 offset:57344
    ds_read_b64_tr_b16 v[46:47], v17 offset:57856
    v_mfma_f32_32x32x16_bf16 v[80:95], v[244:247], v[152:155], v[80:95]
    s_add_u32 m0, s71, 114688
    s_lshl_b32 s64, s30, 7
    buffer_load_dwordx4 v8, s[36:39], s64 offen lds
    s_cmp_eq_u32 s87, 6
    s_cselect_b32 s80, 0x27252624, s80
    s_cselect_b32 s81, 0x2e2928, s81
    s_cmp_eq_u32 s87, 7
    s_cselect_b32 s80, 0x2d2b2c2a, s80
    s_cselect_b32 s81, 0x35342f, s81
    s_bfe_u32 s86, s81, 0x80010
    s_bfe_u32 s85, s81, 0x80008
    v_mfma_f32_32x32x16_bf16 v[64:79], v[32:35], v[156:159], v[64:79]
    ds_read_b128 v[164:167], v14 offset:0
    ds_read_b64_tr_b16 v[240:241], v17 offset:51200
    ds_read_b64_tr_b16 v[242:243], v17 offset:51712
    ds_read_b64_tr_b16 v[244:245], v17 offset:59392
    ds_read_b64_tr_b16 v[246:247], v17 offset:59904
    v_mfma_f32_32x32x16_bf16 v[80:95], v[36:39], v[156:159], v[80:95]
    s_add_u32 m0, s71, 115712
    s_mul_i32 s65, s30, s68
    buffer_load_dwordx4 v9, s[36:39], s64 offen lds
    s_bfe_u32 s84, s81, 0x80000
    s_bfe_u32 s83, s80, 0x80018
    s_bfe_u32 s82, s80, 0x80010
    s_bfe_u32 s81, s80, 0x80008
    s_bfe_u32 s80, s80, 0x80000
    s_mov_b32 s56, s16
    s_and_b32 s57, s17, 0xffff
    s_mov_b32 s58, 1605632
    s_waitcnt lgkmcnt(5)
    v_mfma_f32_32x32x16_bf16 v[64:79], v[40:43], v[160:163], v[64:79]
    ds_read_b128 v[168:171], v15 offset:0
    ds_read_b64_tr_b16 v[32:33], v17 offset:53248
    ds_read_b64_tr_b16 v[34:35], v17 offset:53760
    ds_read_b64_tr_b16 v[36:37], v17 offset:61440
    ds_read_b64_tr_b16 v[38:39], v17 offset:61952
    v_mfma_f32_32x32x16_bf16 v[80:95], v[44:47], v[160:163], v[80:95]
    s_add_u32 m0, s72, 131072
    s_mul_i32 s66, s30, s69
    buffer_load_dwordx4 v10, s[40:43], s65 offen lds
    s_mov_b32 s59, 0x20000
    s_cmp_eq_u32 s28, 7
    s_cselect_b32 s58, 0, s58
    s_add_u32 m0, s72, 139264
    s_add_u32 s30, s30, 1
    buffer_load_dwordx4 v11, s[44:47], s66 offen lds
    s_cmp_eq_u32 s30, 7
    s_cselect_b32 s30, 0, s30
    v_lshrrev_b32 v4, 3, v0
    v_mul_u32_u24 v4, 896, v4
    s_add_u32 m0, s72, 8192
    s_nop 0
    buffer_load_dwordx4 v12, s[48:51], s67 offen lds
    s_add_u32 s67, s67, s70
    s_cmp_eq_u32 s67, s50
    s_cselect_b32 s67, 0, s67
    v_bfe_u32 v5, v0, 4, 1
    v_lshlrev_b32 v5, 2, v5
    s_waitcnt lgkmcnt(5)
    v_mfma_f32_32x32x16_bf16 v[64:79], v[240:243], v[164:167], v[64:79]
    ds_read_b128 v[172:175], v16 offset:0
    ds_read_b64_tr_b16 v[40:41], v17 offset:55296
    ds_read_b64_tr_b16 v[42:43], v17 offset:55808
    ds_read_b64_tr_b16 v[44:45], v17 offset:63488
    ds_read_b64_tr_b16 v[46:47], v17 offset:64000
    v_mfma_f32_32x32x16_bf16 v[80:95], v[244:247], v[164:167], v[80:95]
    s_add_u32 m0, s72, 16384
    s_nop 0
    buffer_load_dwordx4 v12, s[48:51], s67 offen lds
    s_add_u32 s67, s67, s70
    s_cmp_eq_u32 s67, s50
    s_cselect_b32 s67, 0, s67
    v_and_b32 v6, 7, v0
    v_xor_b32 v5, v5, v6
    v_lshl_add_u32 v4, v5, 4, v4
    s_lshl_b32 s31, s95, 7
    v_add_u32 v2, s31, v4
    v_add_u32 v3, 7168, v2
    s_mul_i32 s98, s3, 6144
    s_waitcnt lgkmcnt(0)
    s_waitcnt vmcnt(7)
    s_barrier
    v_mfma_f32_32x32x16_bf16 v[64:79], v[32:35], v[168:171], v[64:79]
    ds_read_b128 v[176:179], v13 offset:16384
    ds_read_b64_tr_b16 v[240:241], v18 offset:32768
    ds_read_b64_tr_b16 v[242:243], v18 offset:33280
    ds_read_b64_tr_b16 v[244:245], v18 offset:40960
    ds_read_b64_tr_b16 v[246:247], v18 offset:41472
    v_mfma_f32_32x32x16_bf16 v[80:95], v[36:39], v[168:171], v[80:95]
    buffer_load_dwordx4 v[208:211], v250, s[52:55], 0 offen sc1
    buffer_load_dwordx4 v[212:215], v21, s[52:55], 0 offen offset:0 sc1
    v_mfma_f32_32x32x16_bf16 v[64:79], v[40:43], v[172:175], v[64:79]
    ds_read_b128 v[180:183], v14 offset:16384
    ds_read_b64_tr_b16 v[32:33], v18 offset:34816
    ds_read_b64_tr_b16 v[34:35], v18 offset:35328
    ds_read_b64_tr_b16 v[36:37], v18 offset:43008
    ds_read_b64_tr_b16 v[38:39], v18 offset:43520
    v_mfma_f32_32x32x16_bf16 v[80:95], v[44:47], v[172:175], v[80:95]
    v_mov_b32 v59, 0
    v_lshlrev_b32 v229, 16, v25
    v_mov_b32 v230, v25
    v_mov_b32 v231, 0
    buffer_load_dwordx4 v[216:219], v21, s[52:55], 0 offen offset:1024 sc1
    buffer_load_dwordx4 v[220:223], v21, s[52:55], 0 offen offset:2048 sc1
    buffer_load_dwordx4 v[224:227], v21, s[52:55], 0 offen offset:3072 sc1
    s_waitcnt lgkmcnt(5)
    v_mfma_f32_32x32x16_bf16 v[64:79], v[240:243], v[176:179], v[64:79]
    ds_read_b128 v[184:187], v15 offset:16384
    ds_read_b64_tr_b16 v[40:41], v18 offset:36864
    ds_read_b64_tr_b16 v[42:43], v18 offset:37376
    ds_read_b64_tr_b16 v[44:45], v18 offset:45056
    ds_read_b64_tr_b16 v[46:47], v18 offset:45568
    v_mfma_f32_32x32x16_bf16 v[80:95], v[244:247], v[176:179], v[80:95]
    s_add_u32 m0, s72, 24576
    s_nop 0
    buffer_load_dwordx4 v12, s[48:51], s67 offen lds
    s_add_u32 s67, s67, s70
    s_cmp_eq_u32 s67, s50
    s_cselect_b32 s67, 0, s67
    v_lshlrev_b32 v233, 16, v26
    v_mov_b32 v234, v26
    v_mov_b32 v235, 0
    v_lshlrev_b32 v61, 16, v27
    v_mov_b32 v62, v27
    v_mov_b32 v63, 0
    s_waitcnt lgkmcnt(5)
    v_mfma_f32_32x32x16_bf16 v[64:79], v[32:35], v[180:183], v[64:79]
    ds_read_b128 v[188:191], v16 offset:16384
    ds_read_b64_tr_b16 v[240:241], v18 offset:38912
    ds_read_b64_tr_b16 v[242:243], v18 offset:39424
    ds_read_b64_tr_b16 v[244:245], v18 offset:47104
    ds_read_b64_tr_b16 v[246:247], v18 offset:47616
    v_mfma_f32_32x32x16_bf16 v[80:95], v[36:39], v[180:183], v[80:95]
    s_add_u32 m0, s72, 32768
    s_nop 0
    buffer_load_dwordx4 v12, s[48:51], s67 offen lds
    s_add_u32 s67, s67, s70
    s_cmp_eq_u32 s67, s50
    s_cselect_b32 s67, 0, s67
    s_add_u32 m0, s72, 40960
    s_nop 0
    buffer_load_dwordx4 v12, s[48:51], s67 offen lds
    s_add_u32 s67, s67, s70
    s_cmp_eq_u32 s67, s50
    s_cselect_b32 s67, 0, s67
    s_waitcnt lgkmcnt(0)
    s_waitcnt vmcnt(10)
    s_barrier
    v_mfma_f32_32x32x16_bf16 v[64:79], v[40:43], v[184:187], v[64:79]
    ds_read_b128 v[192:195], v13 offset:49152
    ds_read_b64_tr_b16 v[32:33], v19 offset:0
    ds_read_b64_tr_b16 v[34:35], v19 offset:512
    ds_read_b64_tr_b16 v[36:37], v19 offset:8192
    ds_read_b64_tr_b16 v[38:39], v19 offset:8704
    v_mfma_f32_32x32x16_bf16 v[80:95], v[44:47], v[184:187], v[80:95]
    s_add_u32 m0, s98, 49152
    s_mul_i32 s93, s80, 28672
    buffer_load_dwordx4 v2, s[56:59], s93 offen lds
    v_mfma_f32_32x32x16_bf16 v[64:79], v[240:243], v[188:191], v[64:79]
    ds_read_b128 v[196:199], v14 offset:49152
    ds_read_b64_tr_b16 v[40:41], v19 offset:2048
    ds_read_b64_tr_b16 v[42:43], v19 offset:2560
    ds_read_b64_tr_b16 v[44:45], v19 offset:10240
    ds_read_b64_tr_b16 v[46:47], v19 offset:10752
    v_mfma_f32_32x32x16_bf16 v[80:95], v[244:247], v[188:191], v[80:95]
    s_add_u32 m0, s98, 50176
    s_nop 0
    buffer_load_dwordx4 v3, s[56:59], s93 offen lds
    s_waitcnt vmcnt(5)
    v_cndmask_b32 v227, v227, v248, s[78:79]
    v_xor_b32 v209, v248, v209
    v_bitop3_b32 v209, v209, v211, v248 bitop3:0xf6
    v_bitop3_b32 v209, v209, v215, v248 bitop3:0xf6
    v_bitop3_b32 v209, v209, v219, v248 bitop3:0xf6
    v_bitop3_b32 v209, v209, v223, v248 bitop3:0xf6
    v_bitop3_b32 v209, v209, v227, v248 bitop3:0xf6
    v_cmp_ne_u32 vcc, 0, v209
    s_nop 1
    s_cmp_lg_u64 vcc, 0
    s_cbranch_scc1 Lvs_4
Lvd_5:
    v_add_f32 v48, 0x3727c5ac, v210
    v_mov_b32 v49, 0x3727c5ac
    v_fma_f32 v49, v49, v48, v210
    v_rsq_f32 v52, v48
    v_rsq_f32 v51, v49
    v_cndmask_b32 v224, v224, 0, s[78:79]
    v_cndmask_b32 v225, v225, 0, s[78:79]
    v_cndmask_b32 v226, v226, 0, s[78:79]
    v_add_f32 v212, v212, v216
    s_waitcnt lgkmcnt(5)
    v_mfma_f32_32x32x16_bf16 v[64:79], v[32:35], v[192:195], v[64:79]
    ds_read_b128 v[200:203], v15 offset:49152
    ds_read_b64_tr_b16 v[240:241], v19 offset:4096
    ds_read_b64_tr_b16 v[242:243], v19 offset:4608
    ds_read_b64_tr_b16 v[244:245], v19 offset:12288
    ds_read_b64_tr_b16 v[246:247], v19 offset:12800
    v_mfma_f32_32x32x16_bf16 v[80:95], v[36:39], v[192:195], v[80:95]
    s_add_u32 m0, s98, 51200
    s_mul_i32 s93, s80, 28672
    s_add_u32 s93, s93, 14336
    buffer_load_dwordx4 v2, s[56:59], s93 offen lds
    v_add_f32 v220, v220, v224
    v_add_f32 v213, v213, v217
    v_add_f32 v221, v221, v225
    v_add_f32 v214, v214, v218
    v_add_f32 v222, v222, v226
    v_add_f32 v212, v212, v220
    v_add_f32 v213, v213, v221
    v_add_f32 v214, v214, v222
    v_mov_b32 v216, v212
    v_mov_b32 v217, v213
    s_waitcnt lgkmcnt(5)
    v_mfma_f32_32x32x16_bf16 v[64:79], v[40:43], v[196:199], v[64:79]
    ds_read_b128 v[204:207], v16 offset:49152
    ds_read_b64_tr_b16 v[32:33], v19 offset:6144
    ds_read_b64_tr_b16 v[34:35], v19 offset:6656
    ds_read_b64_tr_b16 v[36:37], v19 offset:14336
    ds_read_b64_tr_b16 v[38:39], v19 offset:14848
    v_mfma_f32_32x32x16_bf16 v[80:95], v[44:47], v[196:199], v[80:95]
    s_add_u32 m0, s98, 52224
    s_nop 0
    buffer_load_dwordx4 v3, s[56:59], s93 offen lds
    v_mov_b32 v218, v214
    v_permlane32_swap_b32 v212, v216
    v_permlane32_swap_b32 v213, v217
    v_permlane32_swap_b32 v214, v218
    v_add_f32 v220, v212, v216
    v_add_f32 v221, v213, v217
    v_add_f32 v222, v214, v218
    v_mul_f32 v26, v49, v51
    v_cvt_pk_bf16_f32 v236, -v208, v26
    v_lshlrev_b32 v237, 16, v236
    s_waitcnt lgkmcnt(0)
    s_barrier
    v_mfma_f32_32x32x16_bf16 v[64:79], v[240:243], v[200:203], v[64:79]
    v_mfma_f32_32x32x16_bf16 v[80:95], v[244:247], v[200:203], v[80:95]
    s_add_u32 m0, s98, 53248
    s_mul_i32 s93, s81, 28672
    buffer_load_dwordx4 v2, s[56:59], s93 offen lds
    v_and_b32 v238, 0xffff0000, v236
    v_sub_f32 v237, -v208, v237
    v_sub_f32 v238, v26, v238
    v_cvt_pk_bf16_f32 v239, -v208, v237
    v_cvt_pk_bf16_f32 v238, v238, 0
    v_cndmask_b32 v56, v239, 0, s[78:79]
    v_cndmask_b32 v57, v236, 0, s[78:79]
    v_cndmask_b32 v58, v238, 0, s[78:79]
    v_cvt_pk_bf16_f32 v228, v220, v220
    v_and_b32 v236, 0xffff0000, v228
    v_mfma_f32_32x32x16_bf16 v[64:79], v[32:35], v[204:207], v[64:79]
    v_mfma_f32_32x32x16_bf16 v[80:95], v[36:39], v[204:207], v[80:95]
    s_add_u32 m0, s98, 54272
    s_nop 0
    buffer_load_dwordx4 v3, s[56:59], s93 offen lds
    v_sub_f32 v236, v220, v236
    v_cvt_pk_bf16_f32 v229, v236, v229
    v_cvt_pk_bf16_f32 v232, v221, v221
    v_and_b32 v236, 0xffff0000, v232
    v_sub_f32 v236, v221, v236
    v_cvt_pk_bf16_f32 v233, v236, v233
    v_cvt_pk_bf16_f32 v60, v222, v222
    v_and_b32 v236, 0xffff0000, v60
    v_sub_f32 v236, v222, v236
    v_cvt_pk_bf16_f32 v61, v236, v61
    v_mfma_f32_32x32x16_bf16 v[64:79], v[228:231], v[56:59], v[64:79]
    v_mul_f32 v48, 0xc0135761, v51
    v_mul_f32 v53, v51, v51
    v_mfma_f32_32x32x16_bf16 v[80:95], v[232:235], v[56:59], v[80:95]
    v_mul_f32 v53, 0x3d372713, v53
    v_mul_f32 v50, v53, v48
    v_mul_f32 v54, 0x3fb8aa3b, v52
    s_cmp_eq_u32 s74, 0
    s_cbranch_scc1 Lp1a
    s_add_u32 m0, s98, 98304
    s_mul_i32 s93, s81, 28672
    s_add_u32 s93, s93, 14336
    buffer_load_dwordx4 v2, s[56:59], s93 offen lds
    s_add_u32 m0, s98, 99328
    s_nop 0
    buffer_load_dwordx4 v3, s[56:59], s93 offen lds
    s_add_u32 m0, s98, 100352
    s_mul_i32 s93, s82, 28672
    buffer_load_dwordx4 v2, s[56:59], s93 offen lds
    s_add_u32 m0, s98, 101376
    s_nop 0
    buffer_load_dwordx4 v3, s[56:59], s93 offen lds
    s_add_u32 m0, s98, 102400
    s_mul_i32 s93, s82, 28672
    s_add_u32 s93, s93, 14336
    buffer_load_dwordx4 v2, s[56:59], s93 offen lds
    s_add_u32 m0, s98, 103424
    s_nop 0
    buffer_load_dwordx4 v3, s[56:59], s93 offen lds
Lp1a:
    s_nop 3
    s_cmp_ge_u32 s92, 10
    s_cbranch_scc1 Lphi0
    v_pk_mul_f32 v[32:33], v[64:65], v[64:65]
    v_pk_mul_f32 v[34:35], v[66:67], v[66:67]
    v_pk_mul_f32 v[36:37], v[68:69], v[68:69]
    v_pk_mul_f32 v[38:39], v[70:71], v[70:71]
    v_pk_fma_f32 v[32:33], v[32:33], v[50:51], v[48:49] op_sel_hi:[1,0,0]
    v_pk_fma_f32 v[34:35], v[34:35], v[50:51], v[48:49] op_sel_hi:[1,0,0]
    v_pk_fma_f32 v[36:37], v[36:37], v[50:51], v[48:49] op_sel_hi:[1,0,0]
    v_pk_fma_f32 v[38:39], v[38:39], v[50:51], v[48:49] op_sel_hi:[1,0,0]
    v_pk_mul_f32 v[32:33], v[32:33], v[64:65]
    v_pk_mul_f32 v[34:35], v[34:35], v[66:67]
    v_pk_mul_f32 v[36:37], v[36:37], v[68:69]
    v_pk_mul_f32 v[38:39], v[38:39], v[70:71]
    v_exp_f32 v32, v32
    v_exp_f32 v33, v33
    v_exp_f32 v34, v34
    v_exp_f32 v35, v35
    v_exp_f32 v36, v36
    v_exp_f32 v37, v37
    v_exp_f32 v38, v38
    v_exp_f32 v39, v39
    v_pk_fma_f32 v[32:33], v[32:33], v[26:27], v[26:27] op_sel_hi:[1,0,0]
    v_pk_fma_f32 v[34:35], v[34:35], v[26:27], v[26:27] op_sel_hi:[1,0,0]
    v_pk_fma_f32 v[36:37], v[36:37], v[26:27], v[26:27] op_sel_hi:[1,0,0]
    v_pk_fma_f32 v[38:39], v[38:39], v[26:27], v[26:27] op_sel_hi:[1,0,0]
    v_rcp_f32 v32, v32
    v_rcp_f32 v33, v33
    v_rcp_f32 v34, v34
    v_rcp_f32 v35, v35
    v_rcp_f32 v36, v36
    v_rcp_f32 v37, v37
    v_rcp_f32 v38, v38
    v_rcp_f32 v39, v39
    v_pk_mul_f32 v[32:33], v[32:33], v[64:65]
    v_pk_mul_f32 v[34:35], v[34:35], v[66:67]
    v_pk_mul_f32 v[36:37], v[36:37], v[68:69]
    v_pk_mul_f32 v[38:39], v[38:39], v[70:71]
    v_cvt_pk_bf16_f32 v208, v32, v33
    v_cvt_pk_bf16_f32 v209, v34, v35
    v_cvt_pk_bf16_f32 v210, v36, v37
    v_cvt_pk_bf16_f32 v211, v38, v39
    buffer_store_dwordx4 v[208:211], v1, s[52:55], s10 offen offset:0 sc1
    v_pk_mul_f32 v[40:41], v[72:73], v[72:73]
    v_pk_mul_f32 v[42:43], v[74:75], v[74:75]
    v_pk_mul_f32 v[44:45], v[76:77], v[76:77]
    v_pk_mul_f32 v[46:47], v[78:79], v[78:79]
    v_pk_fma_f32 v[40:41], v[40:41], v[50:51], v[48:49] op_sel_hi:[1,0,0]
    v_pk_fma_f32 v[42:43], v[42:43], v[50:51], v[48:49] op_sel_hi:[1,0,0]
    v_pk_fma_f32 v[44:45], v[44:45], v[50:51], v[48:49] op_sel_hi:[1,0,0]
    v_pk_fma_f32 v[46:47], v[46:47], v[50:51], v[48:49] op_sel_hi:[1,0,0]
    v_pk_mul_f32 v[40:41], v[40:41], v[72:73]
    v_pk_mul_f32 v[42:43], v[42:43], v[74:75]
    v_pk_mul_f32 v[44:45], v[44:45], v[76:77]
    v_pk_mul_f32 v[46:47], v[46:47], v[78:79]
    v_exp_f32 v40, v40
    v_exp_f32 v41, v41
    v_exp_f32 v42, v42
    v_exp_f32 v43, v43
    v_exp_f32 v44, v44
    v_exp_f32 v45, v45
    v_exp_f32 v46, v46
    v_exp_f32 v47, v47
    v_pk_fma_f32 v[40:41], v[40:41], v[26:27], v[26:27] op_sel_hi:[1,0,0]
    v_pk_fma_f32 v[42:43], v[42:43], v[26:27], v[26:27] op_sel_hi:[1,0,0]
    v_pk_fma_f32 v[44:45], v[44:45], v[26:27], v[26:27] op_sel_hi:[1,0,0]
    v_pk_fma_f32 v[46:47], v[46:47], v[26:27], v[26:27] op_sel_hi:[1,0,0]
    v_rcp_f32 v40, v40
    v_rcp_f32 v41, v41
    v_rcp_f32 v42, v42
    v_rcp_f32 v43, v43
    v_rcp_f32 v44, v44
    v_rcp_f32 v45, v45
    v_rcp_f32 v46, v46
    v_rcp_f32 v47, v47
    v_pk_mul_f32 v[40:41], v[40:41], v[72:73]
    v_pk_mul_f32 v[42:43], v[42:43], v[74:75]
    v_pk_mul_f32 v[44:45], v[44:45], v[76:77]
    v_pk_mul_f32 v[46:47], v[46:47], v[78:79]
    v_cvt_pk_bf16_f32 v212, v40, v41
    v_cvt_pk_bf16_f32 v213, v42, v43
    v_cvt_pk_bf16_f32 v214, v44, v45
    v_cvt_pk_bf16_f32 v215, v46, v47
    buffer_store_dwordx4 v[212:215], v1, s[52:55], s10 offen offset:1024 sc1
    s_add_u32 s10, s10, 4096
    s_cmp_eq_u32 s92, 9
    s_cbranch_scc1 Lphi1
    v_pk_mul_f32 v[32:33], v[80:81], v[80:81]
    v_pk_mul_f32 v[34:35], v[82:83], v[82:83]
    v_pk_mul_f32 v[36:37], v[84:85], v[84:85]
    v_pk_mul_f32 v[38:39], v[86:87], v[86:87]
    v_pk_fma_f32 v[32:33], v[32:33], v[50:51], v[48:49] op_sel_hi:[1,0,0]
    v_pk_fma_f32 v[34:35], v[34:35], v[50:51], v[48:49] op_sel_hi:[1,0,0]
    v_pk_fma_f32 v[36:37], v[36:37], v[50:51], v[48:49] op_sel_hi:[1,0,0]
    v_pk_fma_f32 v[38:39], v[38:39], v[50:51], v[48:49] op_sel_hi:[1,0,0]
    v_pk_mul_f32 v[32:33], v[32:33], v[80:81]
    v_pk_mul_f32 v[34:35], v[34:35], v[82:83]
    v_pk_mul_f32 v[36:37], v[36:37], v[84:85]
    v_pk_mul_f32 v[38:39], v[38:39], v[86:87]
    v_exp_f32 v32, v32
    v_exp_f32 v33, v33
    v_exp_f32 v34, v34
    v_exp_f32 v35, v35
    v_exp_f32 v36, v36
    v_exp_f32 v37, v37
    v_exp_f32 v38, v38
    v_exp_f32 v39, v39
    v_pk_fma_f32 v[32:33], v[32:33], v[26:27], v[26:27] op_sel_hi:[1,0,0]
    v_pk_fma_f32 v[34:35], v[34:35], v[26:27], v[26:27] op_sel_hi:[1,0,0]
    v_pk_fma_f32 v[36:37], v[36:37], v[26:27], v[26:27] op_sel_hi:[1,0,0]
    v_pk_fma_f32 v[38:39], v[38:39], v[26:27], v[26:27] op_sel_hi:[1,0,0]
    v_rcp_f32 v32, v32
    v_rcp_f32 v33, v33
    v_rcp_f32 v34, v34
    v_rcp_f32 v35, v35
    v_rcp_f32 v36, v36
    v_rcp_f32 v37, v37
    v_rcp_f32 v38, v38
    v_rcp_f32 v39, v39
    v_pk_mul_f32 v[32:33], v[32:33], v[80:81]
    v_pk_mul_f32 v[34:35], v[34:35], v[82:83]
    v_pk_mul_f32 v[36:37], v[36:37], v[84:85]
    v_pk_mul_f32 v[38:39], v[38:39], v[86:87]
    v_cvt_pk_bf16_f32 v216, v32, v33
    v_cvt_pk_bf16_f32 v217, v34, v35
    v_cvt_pk_bf16_f32 v218, v36, v37
    v_cvt_pk_bf16_f32 v219, v38, v39
    buffer_store_dwordx4 v[216:219], v1, s[52:55], s10 offen offset:0 sc1
    v_pk_mul_f32 v[40:41], v[88:89], v[88:89]
    v_pk_mul_f32 v[42:43], v[90:91], v[90:91]
    v_pk_mul_f32 v[44:45], v[92:93], v[92:93]
    v_pk_mul_f32 v[46:47], v[94:95], v[94:95]
    v_pk_fma_f32 v[40:41], v[40:41], v[50:51], v[48:49] op_sel_hi:[1,0,0]
    v_pk_fma_f32 v[42:43], v[42:43], v[50:51], v[48:49] op_sel_hi:[1,0,0]
    v_pk_fma_f32 v[44:45], v[44:45], v[50:51], v[48:49] op_sel_hi:[1,0,0]
    v_pk_fma_f32 v[46:47], v[46:47], v[50:51], v[48:49] op_sel_hi:[1,0,0]
    v_pk_mul_f32 v[40:41], v[40:41], v[88:89]
    v_pk_mul_f32 v[42:43], v[42:43], v[90:91]
    v_pk_mul_f32 v[44:45], v[44:45], v[92:93]
    v_pk_mul_f32 v[46:47], v[46:47], v[94:95]
    v_exp_f32 v40, v40
    v_exp_f32 v41, v41
    v_exp_f32 v42, v42
    v_exp_f32 v43, v43
    v_exp_f32 v44, v44
    v_exp_f32 v45, v45
    v_exp_f32 v46, v46
    v_exp_f32 v47, v47
    v_pk_fma_f32 v[40:41], v[40:41], v[26:27], v[26:27] op_sel_hi:[1,0,0]
    v_pk_fma_f32 v[42:43], v[42:43], v[26:27], v[26:27] op_sel_hi:[1,0,0]
    v_pk_fma_f32 v[44:45], v[44:45], v[26:27], v[26:27] op_sel_hi:[1,0,0]
    v_pk_fma_f32 v[46:47], v[46:47], v[26:27], v[26:27] op_sel_hi:[1,0,0]
    v_rcp_f32 v40, v40
    v_rcp_f32 v41, v41
    v_rcp_f32 v42, v42
    v_rcp_f32 v43, v43
    v_rcp_f32 v44, v44
    v_rcp_f32 v45, v45
    v_rcp_f32 v46, v46
    v_rcp_f32 v47, v47
    v_pk_mul_f32 v[40:41], v[40:41], v[88:89]
    v_pk_mul_f32 v[42:43], v[42:43], v[90:91]
    v_pk_mul_f32 v[44:45], v[44:45], v[92:93]
    v_pk_mul_f32 v[46:47], v[46:47], v[94:95]
    v_cvt_pk_bf16_f32 v220, v40, v41
    v_cvt_pk_bf16_f32 v221, v42, v43
    v_cvt_pk_bf16_f32 v222, v44, v45
    v_cvt_pk_bf16_f32 v223, v46, v47
    buffer_store_dwordx4 v[220:223], v1, s[52:55], s10 offen offset:1024 sc1
    s_add_u32 s10, s10, 4096
Lepi1:
    s_cmp_lg_u32 s74, 0
    s_cbranch_scc1 Lp1b
    s_add_u32 m0, s98, 98304
    s_mul_i32 s93, s81, 28672
    s_add_u32 s93, s93, 14336
    buffer_load_dwordx4 v2, s[56:59], s93 offen lds
    s_add_u32 m0, s98, 99328
    s_nop 0
    buffer_load_dwordx4 v3, s[56:59], s93 offen lds
    s_add_u32 m0, s98, 100352
    s_mul_i32 s93, s82, 28672
    buffer_load_dwordx4 v2, s[56:59], s93 offen lds
    s_add_u32 m0, s98, 101376
    s_nop 0
    buffer_load_dwordx4 v3, s[56:59], s93 offen lds
    s_add_u32 m0, s98, 102400
    s_mul_i32 s93, s82, 28672
    s_add_u32 s93, s93, 14336
    buffer_load_dwordx4 v2, s[56:59], s93 offen lds
    s_add_u32 m0, s98, 103424
    s_nop 0
    buffer_load_dwordx4 v3, s[56:59], s93 offen lds
Lp1b:
    s_waitcnt vmcnt(10)
    s_barrier
    ds_read_b64_tr_b16 v[32:33], v19 offset:16384
    ds_read_b64_tr_b16 v[34:35], v19 offset:16896
    ds_read_b64_tr_b16 v[36:37], v19 offset:18432
    ds_read_b64_tr_b16 v[38:39], v19 offset:18944
    ds_read_b64_tr_b16 v[40:41], v19 offset:20480
    ds_read_b64_tr_b16 v[42:43], v19 offset:20992
    s_waitcnt lgkmcnt(4)
    v_mfma_f32_32x32x16_bf16 v[64:79], v[32:35], v[96:99], 0
    ds_read_b64_tr_b16 v[44:45], v19 offset:22528
    ds_read_b64_tr_b16 v[46:47], v19 offset:23040
    s_mov_b32 s22, 0x11410040
    s_mov_b32 s23, 0x33321312
    s_cmp_eq_u32 s87, 1
    s_cselect_b32 s22, 0x134910c2, s22
    s_cmp_eq_u32 s3, 1
    s_cselect_b32 s23, 0x14151433, s23
    s_cmp_eq_u32 s87, 2
    s_cselect_b32 s22, 0x22860144, s22
    s_waitcnt lgkmcnt(4)
    v_mfma_f32_32x32x16_bf16 v[64:79], v[36:39], v[100:103], v[64:79]
    ds_read_b64_tr_b16 v[32:33], v17 offset:0
    ds_read_b64_tr_b16 v[34:35], v17 offset:512
    s_cmp_eq_u32 s3, 2
    s_cselect_b32 s23, 0x16353415, s23
    s_cmp_eq_u32 s87, 3
    s_cselect_b32 s22, 0x259231c6, s22
    s_cmp_eq_u32 s3, 3
    s_cselect_b32 s23, 0x17161716, s23
    s_cmp_eq_u32 s87, 4
    s_cselect_b32 s22, 0x289e6248, s22
    s_waitcnt lgkmcnt(4)
    v_mfma_f32_32x32x16_bf16 v[64:79], v[40:43], v[104:107], v[64:79]
    ds_read_b64_tr_b16 v[36:37], v17 offset:2048
    ds_read_b64_tr_b16 v[38:39], v17 offset:2560
    s_cmp_eq_u32 s3, 4
    s_cselect_b32 s23, 0x73725352, s23
    s_cmp_eq_u32 s87, 5
    s_cselect_b32 s22, 0x2baa92ca, s22
    s_cmp_eq_u32 s3, 5
    s_cselect_b32 s23, 0x54555473, s23
    s_cmp_eq_u32 s87, 6
    s_cselect_b32 s22, 0x2eb6c34c, s22
    s_cmp_eq_u32 s3, 6
    s_cselect_b32 s23, 0x56757455, s23
    s_cmp_eq_u32 s87, 7
    s_cselect_b32 s22, 0x31c2f3ce, s22
    s_waitcnt lgkmcnt(4)
    v_mfma_f32_32x32x16_bf16 v[64:79], v[44:47], v[108:111], v[64:79]
    ds_read_b64_tr_b16 v[40:41], v17 offset:4096
    ds_read_b64_tr_b16 v[42:43], v17 offset:4608
    s_cmp_eq_u32 s3, 7
    s_cselect_b32 s23, 0x57565756, s23
    v_and_b32 v4, 31, v0
    v_mul_u32_u24 v4, 6, v4
    v_lshrrev_b32 v5, 5, v0
    v_lshlrev_b32 v5, 6, v5
    s_waitcnt lgkmcnt(4)
    v_mfma_f32_32x32x16_bf16 v[64:79], v[32:35], v[112:115], v[64:79]
    ds_read_b64_tr_b16 v[44:45], v17 offset:6144
    ds_read_b64_tr_b16 v[46:47], v17 offset:6656
    v_bfe_u32 v6, s22, v4, 6
    v_add_u32 v6, v6, v5
    v_add_u32 v4, 12, v4
    v_bfe_u32 v7, s22, v4, 6
    v_add_u32 v7, v7, v5
    v_lshlrev_b32 v4, 3, v0
    v_bfe_u32 v4, s23, v4, 8
    s_mov_b32 s76, 0xf0
    s_mov_b32 s77, 0
    s_waitcnt lgkmcnt(4)
    v_mfma_f32_32x32x16_bf16 v[64:79], v[36:39], v[116:119], v[64:79]
    ds_read_b64_tr_b16 v[32:33], v17 offset:8192
    ds_read_b64_tr_b16 v[34:35], v17 offset:8704
    v_cndmask_b32 v7, v7, v4, s[76:77]
    s_lshl_b32 s31, s96, 14
    s_add_u32 s31, s31, 11534336
    v_lshl_add_u32 v6, v6, 7, s31
    v_lshl_add_u32 v7, v7, 7, s31
    v_mov_b32 v5, 117440512
    s_waitcnt lgkmcnt(4)
    v_mfma_f32_32x32x16_bf16 v[64:79], v[40:43], v[120:123], v[64:79]
    ds_read_b64_tr_b16 v[36:37], v17 offset:10240
    ds_read_b64_tr_b16 v[38:39], v17 offset:10752
    s_mov_b32 s76, 3
    s_mov_b32 s77, 3
    v_cndmask_b32 v23, v5, v6, s[76:77]
    s_mov_b32 s76, 0xf7
    s_mov_b32 s77, 7
    v_cndmask_b32 v252, v5, v7, s[76:77]
    v_lshrrev_b32 v4, 5, v0
    v_lshlrev_b32 v4, 2, v4
    v_bfe_u32 v5, v0, 2, 2
    s_waitcnt lgkmcnt(4)
    v_mfma_f32_32x32x16_bf16 v[64:79], v[44:47], v[124:127], v[64:79]
    ds_read_b64_tr_b16 v[40:41], v17 offset:12288
    ds_read_b64_tr_b16 v[42:43], v17 offset:12800
    v_add_u32 v4, v4, v5
    v_lshlrev_b32 v4, 7, v4
    v_bfe_u32 v5, v0, 4, 1
    v_lshl_add_u32 v4, v5, 5, v4
    v_and_b32 v5, 3, v0
    v_lshl_add_u32 v4, v5, 3, v4
    s_waitcnt lgkmcnt(4)
    v_mfma_f32_32x32x16_bf16 v[64:79], v[32:35], v[128:131], v[64:79]
    ds_read_b64_tr_b16 v[44:45], v17 offset:14336
    ds_read_b64_tr_b16 v[46:47], v17 offset:14848
    v_bfe_u32 v5, v0, 3, 1
    v_lshl_add_u32 v4, v5, 6, v4
    v_add_u32 v6, s98, v4
    v_xor_b32 v7, 64, v6
    v_add_u32 v8, 49152, v6
    v_add_u32 v9, 49152, v7
    v_add_u32 v10, 98304, v6
    v_add_u32 v11, 98304, v7
    s_waitcnt lgkmcnt(4)
    v_mfma_f32_32x32x16_bf16 v[64:79], v[36:39], v[132:135], v[64:79]
    ds_read_b64_tr_b16 v[32:33], v17 offset:16384
    ds_read_b64_tr_b16 v[34:35], v17 offset:16896
    s_waitcnt vmcnt(0)
    buffer_store_dword v248, v249, s[52:55], s11 offen sc1
    s_add_u32 s11, s11, 4096
    s_waitcnt lgkmcnt(4)
    v_mfma_f32_32x32x16_bf16 v[64:79], v[40:43], v[136:139], v[64:79]
    ds_read_b64_tr_b16 v[36:37], v17 offset:18432
    ds_read_b64_tr_b16 v[38:39], v17 offset:18944
    ds_read_b64_tr_b16 v[208:209], v8 offset:0
    ds_read_b64_tr_b16 v[210:211], v8 offset:1024
    ds_read_b64_tr_b16 v[212:213], v9 offset:0
    ds_read_b64_tr_b16 v[214:215], v9 offset:1024
    ds_read_b64_tr_b16 v[216:217], v8 offset:2048
    s_waitcnt lgkmcnt(9)
    v_mfma_f32_32x32x16_bf16 v[64:79], v[44:47], v[140:143], v[64:79]
    ds_read_b64_tr_b16 v[40:41], v17 offset:20480
    ds_read_b64_tr_b16 v[42:43], v17 offset:20992
    ds_read_b64_tr_b16 v[218:219], v8 offset:3072
    ds_read_b64_tr_b16 v[220:221], v9 offset:2048
    ds_read_b64_tr_b16 v[222:223], v9 offset:3072
    ds_read_b64_tr_b16 v[224:225], v8 offset:4096
    ds_read_b64_tr_b16 v[226:227], v8 offset:5120
    s_waitcnt lgkmcnt(14)
    v_mfma_f32_32x32x16_bf16 v[64:79], v[32:35], v[144:147], v[64:79]
    ds_read_b64_tr_b16 v[44:45], v17 offset:22528
    ds_read_b64_tr_b16 v[46:47], v17 offset:23040
    ds_read_b64_tr_b16 v[228:229], v9 offset:4096
    ds_read_b64_tr_b16 v[230:231], v9 offset:5120
    ds_read_b64_tr_b16 v[232:233], v10 offset:0
    ds_read_b64_tr_b16 v[234:235], v10 offset:1024
    ds_read_b64_tr_b16 v[236:237], v11 offset:0
    s_waitcnt lgkmcnt(15)
    v_mfma_f32_32x32x16_bf16 v[64:79], v[36:39], v[148:151], v[64:79]
    ds_read_b64_tr_b16 v[32:33], v17 offset:24576
    ds_read_b64_tr_b16 v[34:35], v17 offset:25088
    ds_read_b64_tr_b16 v[238:239], v11 offset:1024
    ds_read_b64_tr_b16 v[240:241], v10 offset:2048
    ds_read_b64_tr_b16 v[242:243], v10 offset:3072
    ds_read_b64_tr_b16 v[244:245], v11 offset:2048
    ds_read_b64_tr_b16 v[246:247], v11 offset:3072
    s_waitcnt lgkmcnt(15)
    v_mfma_f32_32x32x16_bf16 v[64:79], v[40:43], v[152:155], v[64:79]
    ds_read_b64_tr_b16 v[36:37], v17 offset:26624
    ds_read_b64_tr_b16 v[38:39], v17 offset:27136
    s_waitcnt lgkmcnt(14)
    v_mfma_f32_32x32x16_bf16 v[64:79], v[44:47], v[156:159], v[64:79]
    ds_read_b64_tr_b16 v[40:41], v17 offset:28672
    ds_read_b64_tr_b16 v[42:43], v17 offset:29184
    s_waitcnt lgkmcnt(9)
    v_mfma_f32_32x32x16_bf16 v[64:79], v[32:35], v[160:163], v[64:79]
    ds_read_b64_tr_b16 v[44:45], v17 offset:30720
    ds_read_b64_tr_b16 v[46:47], v17 offset:31232
    s_waitcnt lgkmcnt(6)
    s_waitcnt lgkmcnt(4)
    v_mfma_f32_32x32x16_bf16 v[64:79], v[36:39], v[164:167], v[64:79]
    ds_read_b64_tr_b16 v[32:33], v17 offset:32768
    ds_read_b64_tr_b16 v[34:35], v17 offset:33280
    s_add_u32 m0, s98, 49152
    s_mul_i32 s93, s84, 28672
    s_add_u32 s93, s93, 14336
    buffer_load_dwordx4 v2, s[56:59], s93 offen lds
    s_waitcnt lgkmcnt(4)
    v_mfma_f32_32x32x16_bf16 v[64:79], v[40:43], v[168:171], v[64:79]
    ds_read_b64_tr_b16 v[36:37], v17 offset:34816
    ds_read_b64_tr_b16 v[38:39], v17 offset:35328
    s_add_u32 m0, s98, 50176
    s_nop 0
    buffer_load_dwordx4 v3, s[56:59], s93 offen lds
    s_waitcnt lgkmcnt(4)
    v_mfma_f32_32x32x16_bf16 v[64:79], v[44:47], v[172:175], v[64:79]
    ds_read_b64_tr_b16 v[40:41], v17 offset:36864
    ds_read_b64_tr_b16 v[42:43], v17 offset:37376
    s_add_u32 m0, s98, 51200
    s_mul_i32 s93, s85, 28672
    buffer_load_dwordx4 v2, s[56:59], s93 offen lds
    s_waitcnt lgkmcnt(4)
    v_mfma_f32_32x32x16_bf16 v[64:79], v[32:35], v[176:179], v[64:79]
    ds_read_b64_tr_b16 v[44:45], v17 offset:38912
    ds_read_b64_tr_b16 v[46:47], v17 offset:39424
    s_add_u32 m0, s98, 52224
    s_nop 0
    buffer_load_dwordx4 v3, s[56:59], s93 offen lds
    s_waitcnt lgkmcnt(4)
    v_mfma_f32_32x32x16_bf16 v[64:79], v[36:39], v[180:183], v[64:79]
    ds_read_b64_tr_b16 v[32:33], v17 offset:40960
    ds_read_b64_tr_b16 v[34:35], v17 offset:41472
    s_waitcnt lgkmcnt(4)
    v_mfma_f32_32x32x16_bf16 v[64:79], v[40:43], v[184:187], v[64:79]
    ds_read_b64_tr_b16 v[36:37], v17 offset:43008
    ds_read_b64_tr_b16 v[38:39], v17 offset:43520
    s_add_u32 m0, s98, 53248
    s_mul_i32 s93, s85, 28672
    s_add_u32 s93, s93, 14336
    buffer_load_dwordx4 v2, s[56:59], s93 offen lds
    s_waitcnt lgkmcnt(4)
    v_mfma_f32_32x32x16_bf16 v[64:79], v[44:47], v[188:191], v[64:79]
    ds_read_b64_tr_b16 v[40:41], v17 offset:45056
    ds_read_b64_tr_b16 v[42:43], v17 offset:45568
    s_add_u32 m0, s98, 54272
    s_nop 0
    buffer_load_dwordx4 v3, s[56:59], s93 offen lds
    s_waitcnt lgkmcnt(4)
    v_mfma_f32_32x32x16_bf16 v[64:79], v[32:35], v[192:195], v[64:79]
    ds_read_b64_tr_b16 v[44:45], v17 offset:47104
    ds_read_b64_tr_b16 v[46:47], v17 offset:47616
    s_add_u32 m0, s98, 98304
    s_mul_i32 s93, s86, 28672
    buffer_load_dwordx4 v2, s[56:59], s93 offen lds
    s_waitcnt lgkmcnt(4)
    v_mfma_f32_32x32x16_bf16 v[64:79], v[36:39], v[196:199], v[64:79]
    s_add_u32 m0, s98, 99328
    s_nop 0
    buffer_load_dwordx4 v3, s[56:59], s93 offen lds
    s_waitcnt lgkmcnt(2)
    v_mfma_f32_32x32x16_bf16 v[64:79], v[40:43], v[200:203], v[64:79]
    s_add_u32 m0, s98, 100352
    s_mul_i32 s93, s86, 28672
    s_add_u32 s93, s93, 14336
    buffer_load_dwordx4 v2, s[56:59], s93 offen lds
    s_waitcnt lgkmcnt(0)
    v_mfma_f32_32x32x16_bf16 v[64:79], v[44:47], v[204:207], v[64:79]
    s_add_u32 m0, s98, 101376
    s_nop 0
    buffer_load_dwordx4 v3, s[56:59], s93 offen lds
    v_mfma_f32_32x32x16_bf16 v[64:79], v[60:63], v[56:59], v[64:79]
    s_barrier
    buffer_load_dword v24, v23, s[52:55], 0 offen sc1
    s_mov_b32 s75, s74
    s_cmp_eq_u32 s74, 0
    s_cbranch_scc1 Lp2a
    s_add_u32 m0, s98, 0
    s_mul_i32 s93, s83, 28672
    buffer_load_dwordx4 v2, s[56:59], s93 offen lds
    s_add_u32 m0, s98, 1024
    s_nop 0
    buffer_load_dwordx4 v3, s[56:59], s93 offen lds
    s_add_u32 m0, s98, 2048
    s_mul_i32 s93, s83, 28672
    s_add_u32 s93, s93, 14336
    buffer_load_dwordx4 v2, s[56:59], s93 offen lds
    s_add_u32 m0, s98, 3072
    s_nop 0
    buffer_load_dwordx4 v3, s[56:59], s93 offen lds
    s_add_u32 m0, s98, 4096
    s_mul_i32 s93, s84, 28672
    buffer_load_dwordx4 v2, s[56:59], s93 offen lds
    s_add_u32 m0, s98, 5120
    s_nop 0
    buffer_load_dwordx4 v3, s[56:59], s93 offen lds
Lp2a:
    s_cmp_eq_u32 s92, 11
    s_cselect_b32 s10, 117440512, s10
    s_nop 7
    s_cmp_ge_u32 s92, 9
    s_cbranch_scc1 Lphi2
    v_pk_mul_f32 v[32:33], v[64:65], v[64:65]
    v_pk_mul_f32 v[34:35], v[66:67], v[66:67]
    v_pk_mul_f32 v[36:37], v[68:69], v[68:69]
    v_pk_mul_f32 v[38:39], v[70:71], v[70:71]
    v_pk_fma_f32 v[32:33], v[32:33], v[50:51], v[48:49] op_sel_hi:[1,0,0]
    v_pk_fma_f32 v[34:35], v[34:35], v[50:51], v[48:49] op_sel_hi:[1,0,0]
    v_pk_fma_f32 v[36:37], v[36:37], v[50:51], v[48:49] op_sel_hi:[1,0,0]
    v_pk_fma_f32 v[38:39], v[38:39], v[50:51], v[48:49] op_sel_hi:[1,0,0]
    v_pk_mul_f32 v[32:33], v[32:33], v[64:65]
    v_pk_mul_f32 v[34:35], v[34:35], v[66:67]
    v_pk_mul_f32 v[36:37], v[36:37], v[68:69]
    v_pk_mul_f32 v[38:39], v[38:39], v[70:71]
    v_exp_f32 v32, v32
    v_exp_f32 v33, v33
    v_exp_f32 v34, v34
    v_exp_f32 v35, v35
    v_exp_f32 v36, v36
    v_exp_f32 v37, v37
    v_exp_f32 v38, v38
    v_exp_f32 v39, v39
    v_pk_fma_f32 v[32:33], v[32:33], v[26:27], v[26:27] op_sel_hi:[1,0,0]
    v_pk_fma_f32 v[34:35], v[34:35], v[26:27], v[26:27] op_sel_hi:[1,0,0]
    v_pk_fma_f32 v[36:37], v[36:37], v[26:27], v[26:27] op_sel_hi:[1,0,0]
    v_pk_fma_f32 v[38:39], v[38:39], v[26:27], v[26:27] op_sel_hi:[1,0,0]
    v_rcp_f32 v32, v32
    v_rcp_f32 v33, v33
    v_rcp_f32 v34, v34
    v_rcp_f32 v35, v35
    v_rcp_f32 v36, v36
    v_rcp_f32 v37, v37
    v_rcp_f32 v38, v38
    v_rcp_f32 v39, v39
    v_pk_mul_f32 v[32:33], v[32:33], v[64:65]
    v_pk_mul_f32 v[34:35], v[34:35], v[66:67]
    v_pk_mul_f32 v[36:37], v[36:37], v[68:69]
    v_pk_mul_f32 v[38:39], v[38:39], v[70:71]
    v_cvt_pk_bf16_f32 v80, v32, v33
    v_cvt_pk_bf16_f32 v81, v34, v35
    v_cvt_pk_bf16_f32 v82, v36, v37
    v_cvt_pk_bf16_f32 v83, v38, v39
    s_waitcnt vmcnt(0)
    buffer_store_dwordx4 v[80:83], v1, s[52:55], s10 offen offset:0 sc1
    v_pk_mul_f32 v[40:41], v[72:73], v[72:73]
    v_pk_mul_f32 v[42:43], v[74:75], v[74:75]
    v_pk_mul_f32 v[44:45], v[76:77], v[76:77]
    v_pk_mul_f32 v[46:47], v[78:79], v[78:79]
    v_pk_fma_f32 v[40:41], v[40:41], v[50:51], v[48:49] op_sel_hi:[1,0,0]
    v_pk_fma_f32 v[42:43], v[42:43], v[50:51], v[48:49] op_sel_hi:[1,0,0]
    v_pk_fma_f32 v[44:45], v[44:45], v[50:51], v[48:49] op_sel_hi:[1,0,0]
    v_pk_fma_f32 v[46:47], v[46:47], v[50:51], v[48:49] op_sel_hi:[1,0,0]
    v_pk_mul_f32 v[40:41], v[40:41], v[72:73]
    v_pk_mul_f32 v[42:43], v[42:43], v[74:75]
    v_pk_mul_f32 v[44:45], v[44:45], v[76:77]
    v_pk_mul_f32 v[46:47], v[46:47], v[78:79]
    v_exp_f32 v40, v40
    v_exp_f32 v41, v41
    v_exp_f32 v42, v42
    v_exp_f32 v43, v43
    v_exp_f32 v44, v44
    v_exp_f32 v45, v45
    v_exp_f32 v46, v46
    v_exp_f32 v47, v47
    v_pk_fma_f32 v[40:41], v[40:41], v[26:27], v[26:27] op_sel_hi:[1,0,0]
    v_pk_fma_f32 v[42:43], v[42:43], v[26:27], v[26:27] op_sel_hi:[1,0,0]
    v_pk_fma_f32 v[44:45], v[44:45], v[26:27], v[26:27] op_sel_hi:[1,0,0]
    v_pk_fma_f32 v[46:47], v[46:47], v[26:27], v[26:27] op_sel_hi:[1,0,0]
    v_rcp_f32 v40, v40
    v_rcp_f32 v41, v41
    v_rcp_f32 v42, v42
    v_rcp_f32 v43, v43
    v_rcp_f32 v44, v44
    v_rcp_f32 v45, v45
    v_rcp_f32 v46, v46
    v_rcp_f32 v47, v47
    v_pk_mul_f32 v[40:41], v[40:41], v[72:73]
    v_pk_mul_f32 v[42:43], v[42:43], v[74:75]
    v_pk_mul_f32 v[44:45], v[44:45], v[76:77]
    v_pk_mul_f32 v[46:47], v[46:47], v[78:79]
    v_cvt_pk_bf16_f32 v84, v40, v41
    v_cvt_pk_bf16_f32 v85, v42, v43
    v_cvt_pk_bf16_f32 v86, v44, v45
    v_cvt_pk_bf16_f32 v87, v46, v47
    buffer_store_dwordx4 v[84:87], v1, s[52:55], s10 offen offset:1024 sc1
    s_add_u32 s10, s10, 4096
Lp2:
    s_cmp_lg_u32 s74, 0
    s_cbranch_scc1 Lprio
    s_setprio 0
Lprio:
    s_mul_i32 s32, s96, 286720
    s_add_u32 s32, s32, 2097152
    s_mul_i32 s31, s74, 143360
    s_add_u32 s34, s32, s31
    v_add_u32 v4, s34, v1
    s_sub_u32 s32, s32, s31
    s_add_u32 s32, s32, 143360
    v_add_u32 v5, s32, v1
    s_mov_b32 s60, s18
    s_and_b32 s61, s19, 0xffff
    s_mov_b32 s62, 896
    s_mov_b32 s63, 0x20000
    v_lshrrev_b32 v12, 3, v0
    s_lshl_b32 s31, s96, 6
    s_lshl_b32 s32, s3, 3
    s_add_u32 s31, s31, s32
    v_add_u32 v12, s31, v12
    v_mul_u32_u24 v12, 896, v12
    v_and_b32 v13, 7, v0
    v_lshlrev_b32 v13, 4, v13
    s_lshl_b32 s31, s95, 7
    v_add_u32 v13, s31, v13
    v_add_u32 v12, v12, v13
    s_lshl_b32 s40, s80, 11
    s_lshl_b32 s41, s81, 11
    s_lshl_b32 s42, s82, 11
    s_lshl_b32 s43, s83, 11
    s_lshl_b32 s44, s84, 11
    s_lshl_b32 s45, s85, 11
    s_lshl_b32 s46, s86, 11
    s_waitcnt vmcnt(0)
    buffer_store_dword v248, v249, s[52:55], s11 offen sc1
    v_cmp_ne_u32 vcc, s94, v24
    s_mov_b32 s76, 0x3
    s_mov_b32 s77, 0x3
    s_and_b64 vcc, vcc, s[76:77]
    s_cbranch_scc1 Lvs_7
Lvd_8:
    buffer_load_dwordx4 v[96:99], v4, s[52:55], s40 offen offset:0 sc1
    buffer_load_dwordx4 v[100:103], v5, s[52:55], s40 offen offset:0 sc1
    buffer_load_dwordx4 v[104:107], v4, s[52:55], s40 offen offset:1024 sc1
    buffer_load_dwordx4 v[108:111], v5, s[52:55], s40 offen offset:1024 sc1
    buffer_load_dwordx4 v[112:115], v4, s[52:55], s41 offen offset:0 sc1
    buffer_load_dwordx4 v[116:119], v5, s[52:55], s41 offen offset:0 sc1
    buffer_load_dwordx4 v[120:123], v4, s[52:55], s41 offen offset:1024 sc1
    buffer_load_dwordx4 v[124:127], v5, s[52:55], s41 offen offset:1024 sc1
    buffer_load_dwordx4 v[128:131], v4, s[52:55], s42 offen offset:0 sc1
    buffer_load_dwordx4 v[132:135], v5, s[52:55], s42 offen offset:0 sc1
    buffer_load_dwordx4 v[136:139], v4, s[52:55], s42 offen offset:1024 sc1
    buffer_load_dwordx4 v[140:143], v5, s[52:55], s42 offen offset:1024 sc1
    s_cmp_lg_u32 s75, 0
    s_cbranch_scc1 Lnolate2
    s_add_u32 m0, s98, 0
    s_mul_i32 s93, s83, 28672
    buffer_load_dwordx4 v2, s[56:59], s93 offen lds
    s_add_u32 m0, s98, 1024
    s_nop 0
    buffer_load_dwordx4 v3, s[56:59], s93 offen lds
    s_add_u32 m0, s98, 2048
    s_mul_i32 s93, s83, 28672
    s_add_u32 s93, s93, 14336
    buffer_load_dwordx4 v2, s[56:59], s93 offen lds
    s_add_u32 m0, s98, 3072
    s_nop 0
    buffer_load_dwordx4 v3, s[56:59], s93 offen lds
    s_add_u32 m0, s98, 4096
    s_mul_i32 s93, s84, 28672
    buffer_load_dwordx4 v2, s[56:59], s93 offen lds
    s_add_u32 m0, s98, 5120
    s_nop 0
    buffer_load_dwordx4 v3, s[56:59], s93 offen lds
Lnolate2:
    s_mul_i32 s65, s73, 7168
    s_add_u32 s66, s65, 114688
    s_add_u32 s67, s66, 4096
    v_mov_b32 v3, v12
    v_lshrrev_b32 v2, 5, v0
    v_lshlrev_b32 v2, 4, v2
    s_waitcnt vmcnt(11)
    v_mfma_f32_32x32x16_bf16 v[32:47], v[208:211], v[96:99], 0
    buffer_load_dwordx4 v[144:147], v4, s[52:55], s43 offen offset:0 sc1
    v_mfma_f32_32x32x16_bf16 v[48:63], v[212:215], v[96:99], 0
    buffer_load_dwordx4 v[148:151], v5, s[52:55], s43 offen offset:0 sc1
    s_waitcnt vmcnt(12)
    v_mfma_f32_32x32x16_bf16 v[64:79], v[208:211], v[100:103], 0
    buffer_load_dwordx4 v[152:155], v4, s[52:55], s43 offen offset:1024 sc1
    v_mfma_f32_32x32x16_bf16 v[80:95], v[212:215], v[100:103], 0
    buffer_load_dwordx4 v[156:159], v5, s[52:55], s43 offen offset:1024 sc1
    s_waitcnt vmcnt(13)
    v_mfma_f32_32x32x16_bf16 v[32:47], v[216:219], v[104:107], v[32:47]
    v_mfma_f32_32x32x16_bf16 v[48:63], v[220:223], v[104:107], v[48:63]
    buffer_load_dword v24, v252, s[52:55], 0 offen sc1
    s_waitcnt vmcnt(13)
    v_mfma_f32_32x32x16_bf16 v[64:79], v[216:219], v[108:111], v[64:79]
    buffer_load_dwordx4 v[248:251], v13, s[60:63], 0 offen
    v_mfma_f32_32x32x16_bf16 v[80:95], v[220:223], v[108:111], v[80:95]
    buffer_load_dwordx4 v[12:15], v3, s[36:39], 0 offen
    s_waitcnt vmcnt(14)
    v_mfma_f32_32x32x16_bf16 v[32:47], v[224:227], v[112:115], v[32:47]
    v_mfma_f32_32x32x16_bf16 v[48:63], v[228:231], v[112:115], v[48:63]
    s_waitcnt vmcnt(13)
    v_mfma_f32_32x32x16_bf16 v[64:79], v[224:227], v[116:119], v[64:79]
    v_mfma_f32_32x32x16_bf16 v[80:95], v[228:231], v[116:119], v[80:95]
    s_waitcnt vmcnt(12)
    v_mfma_f32_32x32x16_bf16 v[32:47], v[232:235], v[120:123], v[32:47]
    v_mfma_f32_32x32x16_bf16 v[48:63], v[236:239], v[120:123], v[48:63]
    s_waitcnt vmcnt(11)
    v_mfma_f32_32x32x16_bf16 v[64:79], v[232:235], v[124:127], v[64:79]
    v_mfma_f32_32x32x16_bf16 v[80:95], v[236:239], v[124:127], v[80:95]
    s_waitcnt vmcnt(2)
    v_cmp_ne_u32 vcc, s94, v24
    s_mov_b32 s76, 0xf7
    s_mov_b32 s77, 0x7
    s_and_b64 vcc, vcc, s[76:77]
    s_cbranch_scc1 Lvs_10
Lvd_11:
    v_mfma_f32_32x32x16_bf16 v[32:47], v[240:243], v[128:131], v[32:47]
    ds_read_b64_tr_b16 v[24:25], v10 offset:4096
    ds_read_b64_tr_b16 v[26:27], v10 offset:5120
    v_mfma_f32_32x32x16_bf16 v[48:63], v[244:247], v[128:131], v[48:63]
    ds_read_b64_tr_b16 v[28:29], v11 offset:4096
    ds_read_b64_tr_b16 v[30:31], v11 offset:5120
    v_mfma_f32_32x32x16_bf16 v[64:79], v[240:243], v[132:135], v[64:79]
    buffer_load_dwordx4 v[160:163], v4, s[52:55], s44 offen offset:0 sc1
    buffer_load_dwordx4 v[164:167], v5, s[52:55], s44 offen offset:0 sc1
    v_mfma_f32_32x32x16_bf16 v[80:95], v[244:247], v[132:135], v[80:95]
    buffer_load_dwordx4 v[168:171], v4, s[52:55], s44 offen offset:1024 sc1
    buffer_load_dwordx4 v[172:175], v5, s[52:55], s44 offen offset:1024 sc1
    s_waitcnt lgkmcnt(2)
    v_mfma_f32_32x32x16_bf16 v[32:47], v[24:27], v[136:139], v[32:47]
    ds_read_b64_tr_b16 v[16:17], v6 offset:0
    ds_read_b64_tr_b16 v[18:19], v6 offset:1024
    ds_read_b64_tr_b16 v[20:21], v7 offset:0
    s_waitcnt lgkmcnt(3)
    v_mfma_f32_32x32x16_bf16 v[48:63], v[28:31], v[136:139], v[48:63]
    ds_read_b64_tr_b16 v[22:23], v7 offset:1024
    buffer_load_dwordx4 v[96:99], v4, s[52:55], s66 offen offset:0 sc1
    buffer_load_dwordx4 v[100:103], v4, s[52:55], s66 offen offset:1024 sc1
    v_mfma_f32_32x32x16_bf16 v[64:79], v[24:27], v[140:143], v[64:79]
    buffer_load_dwordx4 v[104:107], v4, s[52:55], s66 offen offset:2048 sc1
    buffer_load_dwordx4 v[108:111], v4, s[52:55], s66 offen offset:3072 sc1
    v_mul_u32_u24 v208, 37, v0
    v_lshrrev_b32 v208, 9, v208
    v_lshlrev_b32 v209, 3, v0
    v_mfma_f32_32x32x16_bf16 v[80:95], v[28:31], v[140:143], v[80:95]
    v_lshl_add_u32 v209, v208, 4, v209
    s_lshl_b32 s34, s73, 9
    s_add_u32 s93, s34, 4096
    v_add_u32 v209, s93, v209
    s_lshl_b32 s93, s95, 12
    s_add_u32 s93, s93, s34
    s_lshl_b32 s34, s74, 11
    s_add_u32 s93, s93, s34
    s_add_u32 s93, s93, 8192
    s_waitcnt lgkmcnt(2)
    v_mfma_f32_32x32x16_bf16 v[32:47], v[16:19], v[144:147], v[32:47]
    ds_read_b64_tr_b16 v[24:25], v6 offset:2048
    ds_read_b64_tr_b16 v[26:27], v6 offset:3072
    ds_read_b64_tr_b16 v[28:29], v7 offset:2048
    s_waitcnt lgkmcnt(3)
    v_mfma_f32_32x32x16_bf16 v[48:63], v[20:23], v[144:147], v[48:63]
    ds_read_b64_tr_b16 v[30:31], v7 offset:3072
    buffer_load_dwordx4 v[112:115], v4, s[52:55], s67 offen offset:0 sc1
    buffer_load_dwordx4 v[116:119], v4, s[52:55], s67 offen offset:1024 sc1
    v_mfma_f32_32x32x16_bf16 v[64:79], v[16:19], v[148:151], v[64:79]
    buffer_load_dwordx4 v[120:123], v4, s[52:55], s67 offen offset:2048 sc1
    buffer_load_dwordx4 v[176:179], v4, s[52:55], s45 offen offset:0 sc1
    v_and_b32 v210, 3, v0
    v_lshl_add_u32 v210, v210, 7, s93
    v_cmp_gt_u32 vcc, 56, v0
    s_nop 1
    v_cndmask_b32 v236, v210, v209, vcc
    v_mfma_f32_32x32x16_bf16 v[80:95], v[20:23], v[148:151], v[80:95]
    v_lshrrev_b32 v208, 3, v0
    v_lshlrev_b32 v208, 5, v208
    v_bfe_u32 v209, v0, 1, 1
    v_lshl_add_u32 v208, v209, 4, v208
    v_bfe_u32 v209, v0, 2, 1
    v_lshl_add_u32 v208, v209, 3, v208
    v_and_b32 v209, 1, v0
    v_lshl_add_u32 v208, v209, 2, v208
    s_lshl_b32 s93, s3, 8
    s_waitcnt lgkmcnt(2)
    v_mfma_f32_32x32x16_bf16 v[32:47], v[24:27], v[152:155], v[32:47]
    ds_read_b64_tr_b16 v[16:17], v6 offset:4096
    ds_read_b64_tr_b16 v[18:19], v6 offset:5120
    s_waitcnt lgkmcnt(2)
    v_mfma_f32_32x32x16_bf16 v[48:63], v[28:31], v[152:155], v[48:63]
    ds_read_b64_tr_b16 v[20:21], v7 offset:4096
    ds_read_b64_tr_b16 v[22:23], v7 offset:5120
    buffer_load_dwordx4 v[180:183], v5, s[52:55], s45 offen offset:0 sc1
    v_mfma_f32_32x32x16_bf16 v[64:79], v[24:27], v[156:159], v[64:79]
    buffer_load_dwordx4 v[184:187], v4, s[52:55], s45 offen offset:1024 sc1
    buffer_load_dwordx4 v[188:191], v5, s[52:55], s45 offen offset:1024 sc1
    s_add_u32 s93, s93, 157696
    v_add_u32 v237, s93, v208
    v_add_u32 v238, s93, v2
    v_mfma_f32_32x32x16_bf16 v[80:95], v[28:31], v[156:159], v[80:95]
    s_mul_i32 s35, s3, 7168
    s_mul_i32 s31, s95, 57344
    s_add_u32 s31, s31, s35
    s_add_u32 s31, s31, 262144
    s_lshl_b32 s35, s3, 10
    s_add_u32 s35, s35, 147456
    v_and_b32 v245, 15, v0
    v_mul_u32_u24 v239, 272, v245
    v_bfe_u32 v245, v0, 4, 1
    s_waitcnt vmcnt(14) lgkmcnt(2)
    v_mfma_f32_32x32x16_bf16 v[32:47], v[16:19], v[160:163], v[32:47]
    ds_read_b64_tr_b16 v[24:25], v8 offset:0
    ds_read_b64_tr_b16 v[26:27], v8 offset:1024
    ds_read_b64_tr_b16 v[28:29], v9 offset:0
    s_waitcnt lgkmcnt(3)
    v_mfma_f32_32x32x16_bf16 v[48:63], v[20:23], v[160:163], v[48:63]
    ds_read_b64_tr_b16 v[30:31], v9 offset:1024
    buffer_load_dwordx4 v[192:195], v4, s[52:55], s46 offen offset:0 sc1
    buffer_load_dwordx4 v[196:199], v5, s[52:55], s46 offen offset:0 sc1
    s_waitcnt vmcnt(15)
    v_mfma_f32_32x32x16_bf16 v[64:79], v[16:19], v[164:167], v[64:79]
    buffer_load_dwordx4 v[200:203], v4, s[52:55], s46 offen offset:1024 sc1
    buffer_load_dwordx4 v[204:207], v5, s[52:55], s46 offen offset:1024 sc1
    v_mul_u32_u24 v245, 49152, v245
    v_add3_u32 v239, v239, v245, v2
    s_add_u32 s93, s98, 49152
    v_mfma_f32_32x32x16_bf16 v[80:95], v[20:23], v[164:167], v[80:95]
    v_add_u32 v239, s93, v239
    v_lshrrev_b32 v245, 3, v0
    s_and_b32 s93, s73, 1
    v_lshl_add_u32 v245, s93, 3, v245
    v_mul_u32_u24 v241, 272, v245
    v_and_b32 v211, 7, v0
    v_lshl_add_u32 v241, v211, 5, v241
    s_lshr_b32 s93, s73, 1
    s_add_u32 s93, s93, 1
    s_waitcnt vmcnt(16) lgkmcnt(2)
    v_mfma_f32_32x32x16_bf16 v[32:47], v[24:27], v[168:171], v[32:47]
    ds_read_b64_tr_b16 v[16:17], v8 offset:2048
    ds_read_b64_tr_b16 v[18:19], v8 offset:3072
    s_waitcnt lgkmcnt(2)
    v_mfma_f32_32x32x16_bf16 v[48:63], v[28:31], v[168:171], v[48:63]
    ds_read_b64_tr_b16 v[20:21], v9 offset:2048
    ds_read_b64_tr_b16 v[22:23], v9 offset:3072
    s_waitcnt vmcnt(15)
    v_mfma_f32_32x32x16_bf16 v[64:79], v[24:27], v[172:175], v[64:79]
    s_mul_i32 s93, s93, 49152
    s_xor_b32 s34, s74, 1
    s_mul_i32 s34, s34, 24576
    s_add_u32 s93, s93, s34
    v_add_u32 v241, s93, v241
    s_lshl_b32 s93, s3, 13
    v_mfma_f32_32x32x16_bf16 v[80:95], v[28:31], v[172:175], v[80:95]
    s_add_u32 s34, s93, 98304
    s_cmp_ge_u32 s3, 6
    s_cselect_b32 s93, s34, s93
    v_and_b32 v245, 31, v0
    v_lshl_add_u32 v240, v245, 8, s93
    v_and_b32 v245, 7, v0
    s_waitcnt vmcnt(7) lgkmcnt(2)
    v_mfma_f32_32x32x16_bf16 v[32:47], v[16:19], v[176:179], v[32:47]
    ds_read_b64_tr_b16 v[24:25], v8 offset:4096
    ds_read_b64_tr_b16 v[26:27], v8 offset:5120
    s_waitcnt lgkmcnt(2)
    v_mfma_f32_32x32x16_bf16 v[48:63], v[20:23], v[176:179], v[48:63]
    ds_read_b64_tr_b16 v[28:29], v9 offset:4096
    ds_read_b64_tr_b16 v[30:31], v9 offset:5120
    s_waitcnt vmcnt(6)
    v_mfma_f32_32x32x16_bf16 v[64:79], v[16:19], v[180:183], v[64:79]
    v_lshlrev_b32 v245, 4, v245
    v_xor_b32 v245, v245, v2
    v_add_u32 v240, v240, v245
    v_lshrrev_b32 v245, 3, v0
    v_lshlrev_b32 v211, 1, v211
    v_xor_b32 v211, v211, v245
    v_mfma_f32_32x32x16_bf16 v[80:95], v[20:23], v[180:183], v[80:95]
    v_lshlrev_b32 v211, 4, v211
    v_lshl_add_u32 v242, v245, 8, v211
    s_lshl_b32 s93, s73, 11
    s_lshl_b32 s34, s74, 15
    s_add_u32 s93, s93, s34
    v_add_u32 v242, s93, v242
    buffer_load_dwordx2 v[246:247], v236, s[52:55], 0 offen sc1
    s_waitcnt vmcnt(6) lgkmcnt(2)
    v_mfma_f32_32x32x16_bf16 v[32:47], v[24:27], v[184:187], v[32:47]
    ds_read_b64_tr_b16 v[16:17], v10 offset:0
    ds_read_b64_tr_b16 v[18:19], v10 offset:1024
    s_waitcnt lgkmcnt(2)
    v_mfma_f32_32x32x16_bf16 v[48:63], v[28:31], v[184:187], v[48:63]
    ds_read_b64_tr_b16 v[20:21], v11 offset:0
    ds_read_b64_tr_b16 v[22:23], v11 offset:1024
    s_waitcnt vmcnt(5)
    v_mfma_f32_32x32x16_bf16 v[64:79], v[24:27], v[188:191], v[64:79]
    s_mul_i32 s93, s73, 6144
    v_lshlrev_b32 v245, 3, v0
    v_add_u32 v243, s93, v245
    s_lshl_b32 s93, s73, 10
    s_add_u32 s93, s93, 147456
    v_add_u32 v244, s93, v245
    v_mfma_f32_32x32x16_bf16 v[80:95], v[28:31], v[188:191], v[80:95]
    s_mov_b32 s60, s20
    s_and_b32 s61, s21, 0xffff
    s_mov_b32 s62, 1835008
    s_mov_b32 s63, 0x20000
    s_waitcnt vmcnt(4) lgkmcnt(2)
    v_mfma_f32_32x32x16_bf16 v[32:47], v[16:19], v[192:195], v[32:47]
    ds_read_b64_tr_b16 v[24:25], v10 offset:2048
    s_waitcnt lgkmcnt(1)
    v_mfma_f32_32x32x16_bf16 v[48:63], v[20:23], v[192:195], v[48:63]
    ds_read_b64_tr_b16 v[26:27], v10 offset:3072
    s_waitcnt vmcnt(3)
    v_mfma_f32_32x32x16_bf16 v[64:79], v[16:19], v[196:199], v[64:79]
    ds_read_b64_tr_b16 v[28:29], v11 offset:2048
    v_mfma_f32_32x32x16_bf16 v[80:95], v[20:23], v[196:199], v[80:95]
    ds_read_b64_tr_b16 v[30:31], v11 offset:3072
    s_waitcnt vmcnt(1) lgkmcnt(2)
    v_mfma_f32_32x32x16_bf16 v[64:79], v[24:27], v[204:207], v[64:79]
    s_waitcnt lgkmcnt(0)
    v_mfma_f32_32x32x16_bf16 v[80:95], v[28:31], v[204:207], v[80:95]
    v_mfma_f32_32x32x16_bf16 v[32:47], v[24:27], v[200:203], v[32:47]
    v_mfma_f32_32x32x16_bf16 v[48:63], v[28:31], v[200:203], v[48:63]
    v_lshlrev_b32 v16, 16, v12
    v_and_b32 v17, 0xffff0000, v12
    v_lshlrev_b32 v24, 16, v248
    v_and_b32 v25, 0xffff0000, v248
    v_lshlrev_b32 v18, 16, v13
    v_and_b32 v19, 0xffff0000, v13
    v_lshlrev_b32 v26, 16, v249
    v_and_b32 v27, 0xffff0000, v249
    v_lshlrev_b32 v20, 16, v14
    v_and_b32 v21, 0xffff0000, v14
    v_lshlrev_b32 v28, 16, v250
    v_and_b32 v29, 0xffff0000, v250
    v_lshlrev_b32 v22, 16, v15
    v_and_b32 v23, 0xffff0000, v15
    v_lshlrev_b32 v30, 16, v251
    v_and_b32 v31, 0xffff0000, v251
    s_waitcnt vmcnt(0)
    s_mov_b32 s75, 0
    v_cmp_ne_u32 vcc, s94, v247
    s_mov_b32 s76, 0x0
    s_mov_b32 s77, 0xff000000
    s_and_b64 vcc, vcc, s[76:77]
    s_cbranch_scc1 Lnom
    s_mov_b32 s75, 1
    s_add_u32 m0, s98, 0
    s_add_u32 s32, s31, 0
    buffer_load_dwordx4 v1, s[52:55], s32 offen sc1 lds
    s_add_u32 m0, s98, 1024
    s_add_u32 s32, s31, 1024
    buffer_load_dwordx4 v1, s[52:55], s32 offen sc1 lds
    s_add_u32 m0, s98, 2048
    s_add_u32 s32, s31, 2048
    buffer_load_dwordx4 v1, s[52:55], s32 offen sc1 lds
    s_add_u32 m0, s98, 3072
    s_add_u32 s32, s31, 3072
    buffer_load_dwordx4 v1, s[52:55], s32 offen sc1 lds
    s_add_u32 m0, s98, 4096
    s_add_u32 s32, s31, 4096
    buffer_load_dwordx4 v1, s[52:55], s32 offen sc1 lds
    s_add_u32 m0, s98, 5120
    s_add_u32 s32, s31, 5120
    buffer_load_dwordx4 v1, s[52:55], s32 offen sc1 lds
    s_mov_b32 m0, s35
    s_add_u32 s32, s31, 6144
    buffer_load_dwordx4 v1, s[52:55], s32 offen sc1 lds
Lnom:
    ds_write_b128 v239, v[64:67] offset:0
    ds_write_b128 v239, v[68:71] offset:32
    ds_write_b128 v239, v[72:75] offset:64
    ds_write_b128 v239, v[76:79] offset:96
    ds_write_b128 v239, v[80:83] offset:128
    ds_write_b128 v239, v[84:87] offset:160
    ds_write_b128 v239, v[88:91] offset:192
    ds_write_b128 v239, v[92:95] offset:224
    v_add_f32 v16, v16, v24
    v_add_f32 v17, v17, v25
    v_add_f32 v18, v18, v26
    v_add_f32 v19, v19, v27
    v_add_f32 v20, v20, v28
    v_add_f32 v21, v21, v29
    v_add_f32 v22, v22, v30
    v_add_f32 v23, v23, v31
    v_cmp_ne_u32 vcc, s94, v247
    s_mov_b32 s76, 0xffffffff
    s_mov_b32 s77, 0xffffff
    s_and_b64 vcc, vcc, s[76:77]
    s_cbranch_scc1 Lvs_13
Lvd_14:
    ds_write_b32 v237, v246
    ds_read_b128 v[208:211], v238 offset:0
    ds_read_b128 v[212:215], v238 offset:32
    ds_read_b128 v[216:219], v238 offset:64
    ds_read_b128 v[220:223], v238 offset:96
    ds_read_b128 v[224:227], v238 offset:128
    ds_read_b128 v[228:231], v238 offset:160
    ds_read_b128 v[232:235], v238 offset:192
    s_waitcnt lgkmcnt(0)
    s_mov_b32 s76, 0x111
    s_mov_b32 s77, 0x111
    v_cndmask_b32 v208, 0, v208, s[76:77]
    v_cndmask_b32 v209, 0, v209, s[76:77]
    v_cndmask_b32 v210, 0, v210, s[76:77]
    v_cndmask_b32 v211, 0, v211, s[76:77]
    v_cndmask_b32 v212, 0, v212, s[76:77]
    v_cndmask_b32 v213, 0, v213, s[76:77]
    s_mov_b32 s76, 0x111
    s_mov_b32 s77, 0x1022
    v_cndmask_b32 v214, 0, v214, s[76:77]
    v_cndmask_b32 v215, 0, v215, s[76:77]
    v_mfma_f32_32x32x16_bf16 v[128:143], v[208:211], v[96:99], 0
    s_mov_b32 s76, 0x1022
    s_mov_b32 s77, 0x1022
    v_cndmask_b32 v216, 0, v216, s[76:77]
    v_cndmask_b32 v217, 0, v217, s[76:77]
    v_cndmask_b32 v218, 0, v218, s[76:77]
    v_cndmask_b32 v219, 0, v219, s[76:77]
    v_mfma_f32_32x32x16_bf16 v[128:143], v[212:215], v[100:103], v[128:143]
    v_cndmask_b32 v220, 0, v220, s[76:77]
    v_cndmask_b32 v221, 0, v221, s[76:77]
    s_mov_b32 s76, 0x244
    s_mov_b32 s77, 0x244
    v_cndmask_b32 v222, 0, v222, s[76:77]
    v_cndmask_b32 v223, 0, v223, s[76:77]
    v_mfma_f32_32x32x16_bf16 v[128:143], v[216:219], v[104:107], v[128:143]
    v_cndmask_b32 v224, 0, v224, s[76:77]
    v_cndmask_b32 v225, 0, v225, s[76:77]
    v_cndmask_b32 v226, 0, v226, s[76:77]
    v_cndmask_b32 v227, 0, v227, s[76:77]
    v_mfma_f32_32x32x16_bf16 v[128:143], v[220:223], v[108:111], v[128:143]
    s_mov_b32 s76, 0x244
    s_mov_b32 s77, 0x2088
    v_cndmask_b32 v228, 0, v228, s[76:77]
    v_cndmask_b32 v229, 0, v229, s[76:77]
    s_mov_b32 s76, 0x2088
    s_mov_b32 s77, 0x2088
    v_cndmask_b32 v230, 0, v230, s[76:77]
    v_cndmask_b32 v231, 0, v231, s[76:77]
    v_mfma_f32_32x32x16_bf16 v[128:143], v[224:227], v[112:115], v[128:143]
    v_cndmask_b32 v232, 0, v232, s[76:77]
    v_cndmask_b32 v233, 0, v233, s[76:77]
    v_cndmask_b32 v234, 0, v234, s[76:77]
    v_cndmask_b32 v235, 0, v235, s[76:77]
    v_mfma_f32_32x32x16_bf16 v[128:143], v[228:231], v[116:119], v[128:143]
    s_nop 0
    v_mfma_f32_32x32x16_bf16 v[128:143], v[232:235], v[120:123], v[128:143]
    v_lshlrev_b32 v144, 16, v96
    v_and_b32 v145, 0xffff0000, v96
    v_lshlrev_b32 v146, 16, v97
    v_and_b32 v147, 0xffff0000, v97
    v_lshlrev_b32 v148, 16, v98
    v_and_b32 v149, 0xffff0000, v98
    v_lshlrev_b32 v150, 16, v99
    v_and_b32 v151, 0xffff0000, v99
    v_lshlrev_b32 v152, 16, v100
    v_and_b32 v153, 0xffff0000, v100
    v_lshlrev_b32 v154, 16, v101
    v_and_b32 v155, 0xffff0000, v101
    v_lshlrev_b32 v156, 16, v102
    v_and_b32 v157, 0xffff0000, v102
    v_lshlrev_b32 v158, 16, v103
    v_and_b32 v159, 0xffff0000, v103
    v_lshlrev_b32 v160, 16, v104
    v_and_b32 v161, 0xffff0000, v104
    v_lshlrev_b32 v162, 16, v105
    v_and_b32 v163, 0xffff0000, v105
    v_lshlrev_b32 v164, 16, v106
    v_and_b32 v165, 0xffff0000, v106
    v_lshlrev_b32 v166, 16, v107
    v_and_b32 v167, 0xffff0000, v107
    v_lshlrev_b32 v168, 16, v108
    v_and_b32 v169, 0xffff0000, v108
    v_lshlrev_b32 v170, 16, v109
    v_and_b32 v171, 0xffff0000, v109
    v_lshlrev_b32 v172, 16, v110
    v_and_b32 v173, 0xffff0000, v110
    v_lshlrev_b32 v174, 16, v111
    v_and_b32 v175, 0xffff0000, v111
    v_lshlrev_b32 v176, 16, v112
    v_and_b32 v177, 0xffff0000, v112
    v_lshlrev_b32 v178, 16, v113
    v_and_b32 v179, 0xffff0000, v113
    v_lshlrev_b32 v180, 16, v114
    v_and_b32 v181, 0xffff0000, v114
    v_lshlrev_b32 v182, 16, v115
    v_and_b32 v183, 0xffff0000, v115
    v_lshlrev_b32 v184, 16, v116
    v_and_b32 v185, 0xffff0000, v116
    v_lshlrev_b32 v186, 16, v117
    v_and_b32 v187, 0xffff0000, v117
    v_lshlrev_b32 v188, 16, v118
    v_and_b32 v189, 0xffff0000, v118
    v_lshlrev_b32 v190, 16, v119
    v_and_b32 v191, 0xffff0000, v119
    v_lshlrev_b32 v192, 16, v120
    v_and_b32 v193, 0xffff0000, v120
    v_lshlrev_b32 v194, 16, v121
    v_and_b32 v195, 0xffff0000, v121
    v_lshlrev_b32 v196, 16, v122
    v_and_b32 v197, 0xffff0000, v122
    v_lshlrev_b32 v198, 16, v123
    v_and_b32 v199, 0xffff0000, v123
    v_add_f32 v4, s88, v128
    v_add_f32 v6, s88, v129
    v_add_f32 v8, s88, v130
    v_add_f32 v10, s88, v131
    v_add_f32 v12, s88, v132
    v_add_f32 v14, s88, v133
    v_rcp_f32 v4, v4
    v_rcp_f32 v6, v6
    v_rcp_f32 v8, v8
    v_rcp_f32 v10, v10
    v_rcp_f32 v12, v12
    v_rcp_f32 v14, v14
    v_pk_mul_f32 v[144:145], v[144:145], v[4:5] op_sel_hi:[1,0]
    v_pk_mul_f32 v[146:147], v[146:147], v[4:5] op_sel_hi:[1,0]
    v_pk_mul_f32 v[148:149], v[148:149], v[4:5] op_sel_hi:[1,0]
    v_pk_mul_f32 v[150:151], v[150:151], v[4:5] op_sel_hi:[1,0]
    v_pk_mul_f32 v[152:153], v[152:153], v[4:5] op_sel_hi:[1,0]
    v_pk_mul_f32 v[154:155], v[154:155], v[4:5] op_sel_hi:[1,0]
    v_pk_mul_f32 v[156:157], v[156:157], v[12:13] op_sel_hi:[1,0]
    v_pk_mul_f32 v[158:159], v[158:159], v[12:13] op_sel_hi:[1,0]
    v_pk_mul_f32 v[160:161], v[160:161], v[6:7] op_sel_hi:[1,0]
    v_pk_mul_f32 v[162:163], v[162:163], v[6:7] op_sel_hi:[1,0]
    v_pk_mul_f32 v[164:165], v[164:165], v[6:7] op_sel_hi:[1,0]
    v_pk_mul_f32 v[166:167], v[166:167], v[6:7] op_sel_hi:[1,0]
    v_pk_mul_f32 v[168:169], v[168:169], v[6:7] op_sel_hi:[1,0]
    v_pk_mul_f32 v[170:171], v[170:171], v[6:7] op_sel_hi:[1,0]
    v_pk_mul_f32 v[172:173], v[172:173], v[8:9] op_sel_hi:[1,0]
    v_pk_mul_f32 v[174:175], v[174:175], v[8:9] op_sel_hi:[1,0]
    v_pk_mul_f32 v[176:177], v[176:177], v[8:9] op_sel_hi:[1,0]
    v_pk_mul_f32 v[178:179], v[178:179], v[8:9] op_sel_hi:[1,0]
    v_pk_mul_f32 v[180:181], v[180:181], v[8:9] op_sel_hi:[1,0]
    v_pk_mul_f32 v[182:183], v[182:183], v[8:9] op_sel_hi:[1,0]
    v_pk_mul_f32 v[184:185], v[184:185], v[14:15] op_sel_hi:[1,0]
    v_pk_mul_f32 v[186:187], v[186:187], v[14:15] op_sel_hi:[1,0]
    v_pk_mul_f32 v[188:189], v[188:189], v[10:11] op_sel_hi:[1,0]
    v_pk_mul_f32 v[190:191], v[190:191], v[10:11] op_sel_hi:[1,0]
    v_pk_mul_f32 v[192:193], v[192:193], v[10:11] op_sel_hi:[1,0]
    v_pk_mul_f32 v[194:195], v[194:195], v[10:11] op_sel_hi:[1,0]
    v_pk_mul_f32 v[196:197], v[196:197], v[10:11] op_sel_hi:[1,0]
    v_pk_mul_f32 v[198:199], v[198:199], v[10:11] op_sel_hi:[1,0]
    v_cvt_pk_bf16_f32 v96, v144, v145
    v_cvt_pk_bf16_f32 v97, v146, v147
    v_cvt_pk_bf16_f32 v98, v148, v149
    v_cvt_pk_bf16_f32 v99, v150, v151
    v_cvt_pk_bf16_f32 v100, v152, v153
    v_cvt_pk_bf16_f32 v101, v154, v155
    v_cvt_pk_bf16_f32 v102, v156, v157
    v_cvt_pk_bf16_f32 v103, v158, v159
    v_cvt_pk_bf16_f32 v104, v160, v161
    v_cvt_pk_bf16_f32 v105, v162, v163
    v_cvt_pk_bf16_f32 v106, v164, v165
    v_cvt_pk_bf16_f32 v107, v166, v167
    v_cvt_pk_bf16_f32 v108, v168, v169
    v_cvt_pk_bf16_f32 v109, v170, v171
    v_cvt_pk_bf16_f32 v110, v172, v173
    v_cvt_pk_bf16_f32 v111, v174, v175
    v_cvt_pk_bf16_f32 v112, v176, v177
    v_cvt_pk_bf16_f32 v113, v178, v179
    v_cvt_pk_bf16_f32 v114, v180, v181
    v_cvt_pk_bf16_f32 v115, v182, v183
    v_cvt_pk_bf16_f32 v116, v184, v185
    v_cvt_pk_bf16_f32 v117, v186, v187
    v_cvt_pk_bf16_f32 v118, v188, v189
    v_cvt_pk_bf16_f32 v119, v190, v191
    v_cvt_pk_bf16_f32 v120, v192, v193
    v_cvt_pk_bf16_f32 v121, v194, v195
    v_cvt_pk_bf16_f32 v122, v196, v197
    v_cvt_pk_bf16_f32 v123, v198, v199
    s_cmp_lg_u32 s75, 0
    s_cbranch_scc1 Lhavem
    buffer_load_dwordx2 v[246:247], v236, s[52:55], 0 offen sc1
    s_waitcnt vmcnt(0)
    v_cmp_ne_u32 vcc, s94, v247
    s_mov_b32 s76, 0x0
    s_mov_b32 s77, 0xff000000
    s_and_b64 vcc, vcc, s[76:77]
    s_cbranch_scc1 Lvs_16
Lvd_17:
    s_add_u32 m0, s98, 0
    s_add_u32 s32, s31, 0
    buffer_load_dwordx4 v1, s[52:55], s32 offen sc1 lds
    s_add_u32 m0, s98, 1024
    s_add_u32 s32, s31, 1024
    buffer_load_dwordx4 v1, s[52:55], s32 offen sc1 lds
    s_add_u32 m0, s98, 2048
    s_add_u32 s32, s31, 2048
    buffer_load_dwordx4 v1, s[52:55], s32 offen sc1 lds
    s_add_u32 m0, s98, 3072
    s_add_u32 s32, s31, 3072
    buffer_load_dwordx4 v1, s[52:55], s32 offen sc1 lds
    s_add_u32 m0, s98, 4096
    s_add_u32 s32, s31, 4096
    buffer_load_dwordx4 v1, s[52:55], s32 offen sc1 lds
    s_add_u32 m0, s98, 5120
    s_add_u32 s32, s31, 5120
    buffer_load_dwordx4 v1, s[52:55], s32 offen sc1 lds
    s_mov_b32 m0, s35
    s_add_u32 s32, s31, 6144
    buffer_load_dwordx4 v1, s[52:55], s32 offen sc1 lds
Lhavem:
    v_xor_b32 v209, 32, v240
    v_xor_b32 v210, 64, v240
    v_xor_b32 v211, 96, v240
    v_mov_b32 v208, v240
    v_xor_b32 v212, 16, v242
    s_mul_i32 s32, s74, 98304
    v_add_u32 v213, s32, v242
    v_add_u32 v214, s32, v212
    s_waitcnt vmcnt(0)
    s_barrier
    ds_read_b64 v[128:129], v243 offset:0
    ds_read_b64 v[130:131], v243 offset:512
    ds_read_b64 v[132:133], v243 offset:1024
    ds_read_b64 v[134:135], v243 offset:1536
    ds_read_b64 v[136:137], v243 offset:2048
    ds_read_b64 v[138:139], v243 offset:2560
    ds_read_b64 v[140:141], v243 offset:3072
    ds_read_b64 v[142:143], v243 offset:3584
    ds_read_b64 v[144:145], v243 offset:4096
    ds_read_b64 v[146:147], v243 offset:4608
    ds_read_b64 v[148:149], v243 offset:5120
    ds_read_b64 v[150:151], v243 offset:5632
    s_waitcnt lgkmcnt(10)
    v_mfma_f32_32x32x16_bf16 v[32:47], v[128:131], v[96:99], v[32:47]
    ds_read_b64 v[152:153], v244 offset:0
    ds_read_b64 v[154:155], v244 offset:512
    ds_read_b64 v[156:157], v243 offset:24576
    ds_read_b64 v[158:159], v243 offset:25088
    s_waitcnt lgkmcnt(12)
    v_mfma_f32_32x32x16_bf16 v[32:47], v[132:135], v[100:103], v[32:47]
    ds_read_b64 v[160:161], v243 offset:25600
    ds_read_b64 v[162:163], v243 offset:26112
    ds_read_b64 v[164:165], v243 offset:26624
    ds_read_b64 v[166:167], v243 offset:27136
    s_waitcnt lgkmcnt(14)
    v_mfma_f32_32x32x16_bf16 v[32:47], v[136:139], v[104:107], v[32:47]
    ds_read_b64 v[168:169], v243 offset:27648
    ds_read_b64 v[170:171], v243 offset:28160
    ds_read_b64 v[172:173], v243 offset:28672
    ds_read_b64 v[174:175], v243 offset:29184
    s_waitcnt lgkmcnt(15)
    v_mfma_f32_32x32x16_bf16 v[32:47], v[140:143], v[108:111], v[32:47]
    ds_read_b64 v[176:177], v243 offset:29696
    ds_read_b64 v[178:179], v243 offset:30208
    ds_read_b64 v[180:181], v244 offset:4096
    ds_read_b64 v[182:183], v244 offset:4608
    s_waitcnt lgkmcnt(15)
    v_mfma_f32_32x32x16_bf16 v[32:47], v[144:147], v[112:115], v[32:47]
    ds_read_b128 v[64:67], v241 offset:0
    ds_read_b128 v[68:71], v241 offset:16
    ds_read_b128 v[72:75], v241 offset:6144
    ds_read_b128 v[76:79], v241 offset:6160
    ds_read_b128 v[80:83], v241 offset:12288
    ds_read_b128 v[84:87], v241 offset:12304
    ds_read_b128 v[88:91], v241 offset:18432
    ds_read_b128 v[92:95], v241 offset:18448
    v_mfma_f32_32x32x16_bf16 v[32:47], v[148:151], v[116:119], v[32:47]
    s_waitcnt lgkmcnt(15)
    v_mfma_f32_32x32x16_bf16 v[32:47], v[152:155], v[120:123], v[32:47]
    s_waitcnt lgkmcnt(8)
    s_barrier
    v_mfma_f32_32x32x16_bf16 v[48:63], v[156:159], v[96:99], v[48:63]
    s_waitcnt lgkmcnt(6)
    v_add_f32 v16, v16, v64
    v_add_f32 v17, v17, v65
    v_add_f32 v18, v18, v66
    v_add_f32 v19, v19, v67
    v_add_f32 v20, v20, v68
    v_add_f32 v21, v21, v69
    v_add_f32 v22, v22, v70
    v_add_f32 v23, v23, v71
    v_mfma_f32_32x32x16_bf16 v[48:63], v[160:163], v[100:103], v[48:63]
    s_waitcnt lgkmcnt(4)
    v_add_f32 v16, v16, v72
    v_add_f32 v17, v17, v73
    v_add_f32 v18, v18, v74
    v_add_f32 v19, v19, v75
    v_add_f32 v20, v20, v76
    v_add_f32 v21, v21, v77
    v_add_f32 v22, v22, v78
    v_add_f32 v23, v23, v79
    v_mfma_f32_32x32x16_bf16 v[48:63], v[164:167], v[104:107], v[48:63]
    s_waitcnt lgkmcnt(2)
    v_add_f32 v16, v16, v80
    v_add_f32 v17, v17, v81
    v_add_f32 v18, v18, v82
    v_add_f32 v19, v19, v83
    v_add_f32 v20, v20, v84
    v_add_f32 v21, v21, v85
    v_add_f32 v22, v22, v86
    v_add_f32 v23, v23, v87
    v_mfma_f32_32x32x16_bf16 v[48:63], v[168:171], v[108:111], v[48:63]
    ds_write_b128 v208, v[32:35]
    ds_write_b128 v209, v[36:39]
    ds_write_b128 v210, v[40:43]
    ds_write_b128 v211, v[44:47]
    s_waitcnt lgkmcnt(4)
    v_add_f32 v16, v16, v88
    v_add_f32 v17, v17, v89
    v_add_f32 v18, v18, v90
    v_add_f32 v19, v19, v91
    v_add_f32 v20, v20, v92
    v_add_f32 v21, v21, v93
    v_add_f32 v22, v22, v94
    v_add_f32 v23, v23, v95
    v_mfma_f32_32x32x16_bf16 v[48:63], v[172:175], v[112:115], v[48:63]
    v_mfma_f32_32x32x16_bf16 v[48:63], v[176:179], v[116:119], v[48:63]
    v_mfma_f32_32x32x16_bf16 v[48:63], v[180:183], v[120:123], v[48:63]
    s_nop 11
    ds_write_b128 v208, v[48:51] offset:128
    ds_write_b128 v209, v[52:55] offset:128
    ds_write_b128 v210, v[56:59] offset:128
    ds_write_b128 v211, v[60:63] offset:128
    s_waitcnt lgkmcnt(0)
    s_barrier
    ds_read_b128 v[96:99], v242 offset:0
    ds_read_b128 v[100:103], v212 offset:0
    ds_read_b128 v[104:107], v242 offset:8192
    ds_read_b128 v[108:111], v212 offset:8192
    ds_read_b128 v[112:115], v213 offset:16384
    ds_read_b128 v[116:119], v214 offset:16384
    ds_read_b128 v[120:123], v213 offset:24576
    ds_read_b128 v[124:127], v214 offset:24576
    s_waitcnt lgkmcnt(6)
    v_pk_add_f32 v[16:17], v[16:17], v[96:97]
    v_pk_add_f32 v[18:19], v[18:19], v[98:99]
    v_pk_add_f32 v[20:21], v[20:21], v[100:101]
    v_pk_add_f32 v[22:23], v[22:23], v[102:103]
    s_waitcnt lgkmcnt(4)
    v_pk_add_f32 v[16:17], v[16:17], v[104:105]
    v_pk_add_f32 v[18:19], v[18:19], v[106:107]
    v_pk_add_f32 v[20:21], v[20:21], v[108:109]
    v_pk_add_f32 v[22:23], v[22:23], v[110:111]
    s_waitcnt lgkmcnt(2)
    v_pk_add_f32 v[16:17], v[16:17], v[112:113]
    v_pk_add_f32 v[18:19], v[18:19], v[114:115]
    v_pk_add_f32 v[20:21], v[20:21], v[116:117]
    v_pk_add_f32 v[22:23], v[22:23], v[118:119]
    s_waitcnt lgkmcnt(0)
    v_pk_add_f32 v[16:17], v[16:17], v[120:121]
    v_pk_add_f32 v[18:19], v[18:19], v[122:123]
    v_pk_add_f32 v[20:21], v[20:21], v[124:125]
    v_pk_add_f32 v[22:23], v[22:23], v[126:127]
    v_cvt_pk_bf16_f32 v24, v16, v17
    v_cvt_pk_bf16_f32 v25, v18, v19
    v_cvt_pk_bf16_f32 v26, v20, v21
    v_cvt_pk_bf16_f32 v27, v22, v23
    buffer_store_dwordx4 v[24:27], v3, s[60:63], 0 offen
    s_or_b32 s31, s2, s3
    s_cmp_lg_u32 s31, 0
    s_cbranch_scc1 Lend
    v_mov_b32 v4, s94
    v_mov_b32 v5, 0
    s_mov_b64 exec, 1
    buffer_store_dword v4, v5, s[52:55], 0 offen
Lend:
    s_endpgm
Lkv2:
    s_and_b32 s73, s3, 3
    s_lshr_b32 s74, s3, 2
    s_lshl_b32 s34, s74, 13
    v_lshrrev_b32 v4, 2, v0
    v_lshrrev_b32 v5, 4, v0
    v_xor_b32 v4, v4, v5
    v_and_b32 v4, 1, v4
    v_and_b32 v5, 3, v0
    v_or_b32 v4, v4, v5
    v_cmp_eq_u32 vcc, 0, v4
    v_mov_b32 v5, 0x3f803f80
    v_and_b32 v4, 31, v0
    v_cndmask_b32 v28, 0, v5, vcc
    v_cndmask_b32 v29, 0, v5, vcc
    v_cndmask_b32 v30, 0, v5, vcc
    v_cndmask_b32 v31, 0, v5, vcc
    s_add_u32 s34, s34, 0
    v_lshl_add_u32 v5, v4, 7, s34
    v_bfe_u32 v4, v0, 1, 3
    v_lshrrev_b32 v6, 5, v0
    v_xor_b32 v4, v4, v6
    v_lshl_add_u32 v13, v4, 4, v5
    v_xor_b32 v14, 32, v13
    v_xor_b32 v15, 64, v13
    v_xor_b32 v16, 96, v13
    s_lshl_b32 s31, s99, 4
    s_add_u32 s31, s31, 65536
    v_mov_b32 v5, 117440512
    v_mov_b32 v6, s31
    v_cmp_eq_u32 vcc, 63, v0
    s_nop 1
    v_cndmask_b32 v226, v5, v6, vcc
    s_mov_b32 s52, s24
    s_and_b32 s53, s25, 0xffff
    s_mov_b32 s54, 12582912
    s_mov_b32 s55, 0x20000
    s_cmp_eq_u32 s92, 3
    s_cselect_b32 s32, 32, 0
    s_mul_i32 s31, s73, 56
    s_add_u32 s32, s32, s31
    v_bfe_u32 v4, v0, 2, 2
    v_lshl_add_u32 v5, v4, 6, s32
    v_bfe_u32 v6, v0, 4, 1
    v_lshl_add_u32 v5, v6, 5, v5
    v_and_b32 v6, 3, v0
    v_lshl_add_u32 v5, v6, 3, v5
    v_and_b32 v5, 255, v5
    v_lshrrev_b32 v6, 5, v0
    v_lshl_add_u32 v4, v6, 3, v4
    v_lshl_add_u32 v5, v4, 8, v5
    v_add_u32 v17, 16384, v5
    v_add_u32 v18, 65536, v5
    v_add_u32 v19, 114688, v5
    s_add_u32 m0, s71, 49152
    s_lshl_b32 s64, s30, 7
    buffer_load_dwordx4 v8, s[36:39], s64 offen lds
    s_add_u32 m0, s71, 50176
    s_mul_i32 s65, s30, 172032
    buffer_load_dwordx4 v9, s[36:39], s64 offen lds
    s_add_u32 m0, s72, 49152
    s_add_u32 s66, s65, 896
    buffer_load_dwordx4 v10, s[40:43], s65 offen lds
    s_add_u32 m0, s72, 50176
    s_nop 0
    buffer_load_dwordx4 v11, s[40:43], s65 offen lds
    s_add_u32 m0, s72, 65536
    s_nop 0
    buffer_load_dwordx4 v10, s[40:43], s66 offen lds
    s_add_u32 m0, s72, 66560
    s_add_u32 s30, s30, 1
    buffer_load_dwordx4 v11, s[40:43], s66 offen lds
    s_cmp_eq_u32 s30, 7
    s_cselect_b32 s30, 0, s30
    s_cmp_lg_u32 s3, 6
    s_cbranch_scc1 Lpf_19
    s_mul_i32 s31, s2, 6272
    v_min_u32 v4, 48, v0
    v_lshl_add_u32 v4, v4, 7, s31
    global_load_dword v24, v4, s[16:17]
Lpf_19:
    s_cmp_lg_u32 s3, 5
    s_cbranch_scc1 Lpf_20
    s_mul_i32 s31, s2, 1664
    v_min_u32 v4, 12, v0
    v_lshl_add_u32 v4, v4, 7, s31
    v_min_u32 v4, 401404, v4
    global_load_dword v24, v4, s[8:9]
    v_min_u32 v4, 6, v0
    v_lshlrev_b32 v4, 7, v4
    global_load_dword v24, v4, s[18:19]
Lpf_20:
    s_cmp_lg_u32 s3, 4
    s_cbranch_scc1 Lpf_21
    s_lshr_b32 s31, s2, 3
    s_mul_i32 s31, s31, 50176
    s_add_u32 s31, s31, 768
    v_min_u32 v4, 55, v0
    v_mul_u32_u24 v4, 896, v4
    v_add_u32 v4, s31, v4
    global_load_dword v24, v4, s[16:17]
Lpf_21:
    s_waitcnt vmcnt(12)
    v_lshlrev_b32 v212, 16, v208
    v_and_b32 v213, 0xffff0000, v208
    v_lshlrev_b32 v214, 16, v209
    v_and_b32 v215, 0xffff0000, v209
    v_lshlrev_b32 v216, 16, v210
    v_and_b32 v217, 0xffff0000, v210
    v_lshlrev_b32 v218, 16, v211
    v_and_b32 v219, 0xffff0000, v211
    v_pk_add_f32 v[208:209], v[212:213], v[214:215]
    v_pk_add_f32 v[210:211], v[216:217], v[218:219]
    v_pk_add_f32 v[208:209], v[208:209], v[210:211]
    v_add_f32 v224, v208, v209
    s_nop 1
    v_add_f32_dpp v224, v224, v224 quad_perm:[1,0,3,2] row_mask:0xf bank_mask:0xf
    s_nop 1
    v_add_f32_dpp v224, v224, v224 quad_perm:[2,3,0,1] row_mask:0xf bank_mask:0xf
    s_nop 1
    v_add_f32_dpp v224, v224, v224 row_half_mirror row_mask:0xf bank_mask:0xf
    s_nop 1
    v_add_f32_dpp v224, v224, v224 row_mirror row_mask:0xf bank_mask:0xf
    s_nop 1
    v_add_f32_dpp v224, v224, v224 row_bcast:15 row_mask:0xa bank_mask:0xf
    s_nop 1
    v_add_f32_dpp v224, v224, v224 row_bcast:31 row_mask:0xc bank_mask:0xf
    v_mul_f32 v220, 0x3b124925, v224
    s_nop 0
    v_readlane_b32 s99, v220, 63
    s_nop 1
    v_mul_f32 v224, s99, v225
    v_pk_add_f32 v[212:213], v[212:213], v[224:225] op_sel_hi:[1,0] neg_lo:[0,1] neg_hi:[0,1]
    v_pk_add_f32 v[214:215], v[214:215], v[224:225] op_sel_hi:[1,0] neg_lo:[0,1] neg_hi:[0,1]
    v_pk_add_f32 v[216:217], v[216:217], v[224:225] op_sel_hi:[1,0] neg_lo:[0,1] neg_hi:[0,1]
    v_pk_add_f32 v[218:219], v[218:219], v[224:225] op_sel_hi:[1,0] neg_lo:[0,1] neg_hi:[0,1]
    v_pk_mul_f32 v[208:209], v[212:213], v[212:213]
    v_pk_fma_f32 v[208:209], v[214:215], v[214:215], v[208:209]
    v_pk_fma_f32 v[208:209], v[216:217], v[216:217], v[208:209]
    v_pk_fma_f32 v[208:209], v[218:219], v[218:219], v[208:209]
    v_add_f32 v224, v208, v209
    s_nop 1
    v_add_f32_dpp v224, v224, v224 quad_perm:[1,0,3,2] row_mask:0xf bank_mask:0xf
    s_nop 1
    v_add_f32_dpp v224, v224, v224 quad_perm:[2,3,0,1] row_mask:0xf bank_mask:0xf
    s_nop 1
    v_add_f32_dpp v224, v224, v224 row_half_mirror row_mask:0xf bank_mask:0xf
    s_nop 1
    v_add_f32_dpp v224, v224, v224 row_mirror row_mask:0xf bank_mask:0xf
    s_nop 1
    v_add_f32_dpp v224, v224, v224 row_bcast:15 row_mask:0xa bank_mask:0xf
    s_nop 1
    v_add_f32_dpp v224, v224, v224 row_bcast:31 row_mask:0xc bank_mask:0xf
    v_mul_f32 v222, 0x3b124925, v224
    s_waitcnt lgkmcnt(0)
    s_mul_i32 s94, s94, 1664525
    s_add_u32 s94, s94, 1013904223
    v_mov_b32 v248, s94
    v_mov_b32 v221, s94
    v_mov_b32 v223, s94
    buffer_store_dwordx4 v[220:223], v226, s[52:55], 0 offen sc1
    s_waitcnt vmcnt(7)
    s_barrier
    ds_read_b128 v[32:35], v13 offset:0
    ds_read_b64_tr_b16 v[40:41], v17 offset:0
    ds_read_b64_tr_b16 v[42:43], v17 offset:1024
    ds_read_b64_tr_b16 v[44:45], v17 offset:16384
    ds_read_b64_tr_b16 v[46:47], v17 offset:17408
    ds_read_b128 v[36:39], v13 offset:4096
    ds_read_b128 v[48:51], v14 offset:0
    ds_read_b64_tr_b16 v[56:57], v17 offset:4096
    ds_read_b64_tr_b16 v[58:59], v17 offset:5120
    ds_read_b64_tr_b16 v[60:61], v17 offset:20480
    ds_read_b64_tr_b16 v[62:63], v17 offset:21504
    ds_read_b128 v[52:55], v14 offset:4096
    s_waitcnt lgkmcnt(6)
    v_mfma_f32_32x32x16_bf16 v[72:87], v[32:35], v[40:43], 0
    ds_read_b128 v[232:235], v15 offset:0
    ds_read_b64_tr_b16 v[240:241], v17 offset:8192
    ds_read_b64_tr_b16 v[242:243], v17 offset:9216
    ds_read_b64_tr_b16 v[244:245], v17 offset:24576
    ds_read_b64_tr_b16 v[246:247], v17 offset:25600
    ds_read_b128 v[236:239], v15 offset:4096
    v_mfma_f32_32x32x16_bf16 v[88:103], v[32:35], v[44:47], 0
    s_add_u32 m0, s71, 98304
    s_lshl_b32 s64, s30, 7
    buffer_load_dwordx4 v8, s[36:39], s64 offen lds
    v_mfma_f32_32x32x16_bf16 v[104:119], v[36:39], v[40:43], 0
    s_add_u32 m0, s71, 99328
    s_mul_i32 s65, s30, 172032
    buffer_load_dwordx4 v9, s[36:39], s64 offen lds
    v_mfma_f32_32x32x16_bf16 v[120:135], v[36:39], v[44:47], 0
    v_mov_b32 v5, 117440512
    v_lshlrev_b32 v4, 2, v0
    v_cmp_gt_u32 vcc, 32, v0
    s_nop 1
    v_cndmask_b32 v249, v5, v4, vcc
    v_mfma_f32_16x16x32_bf16 v[136:139], v[28:31], v[40:43], 0
    s_add_u32 m0, s72, 98304
    s_add_u32 s66, s65, 896
    buffer_load_dwordx4 v10, s[40:43], s65 offen lds
    v_mfma_f32_16x16x32_bf16 v[140:143], v[28:31], v[44:47], 0
    s_mov_b32 s78, 0
    s_mov_b32 s79, -1
    s_mov_b32 s88, 0x358637bd
    s_waitcnt lgkmcnt(6)
    v_mfma_f32_32x32x16_bf16 v[72:87], v[48:51], v[56:59], v[72:87]
    ds_read_b128 v[32:35], v16 offset:0
    ds_read_b64_tr_b16 v[40:41], v17 offset:12288
    ds_read_b64_tr_b16 v[42:43], v17 offset:13312
    ds_read_b64_tr_b16 v[44:45], v17 offset:28672
    ds_read_b64_tr_b16 v[46:47], v17 offset:29696
    ds_read_b128 v[36:39], v16 offset:4096
    v_mfma_f32_32x32x16_bf16 v[88:103], v[48:51], v[60:63], v[88:103]
    s_add_u32 m0, s72, 99328
    s_nop 0
    buffer_load_dwordx4 v11, s[40:43], s65 offen lds
    v_mfma_f32_32x32x16_bf16 v[104:119], v[52:55], v[56:59], v[104:119]
    s_add_u32 m0, s72, 114688
    s_nop 0
    buffer_load_dwordx4 v10, s[40:43], s66 offen lds
    v_mfma_f32_32x32x16_bf16 v[120:135], v[52:55], v[60:63], v[120:135]
    s_mov_b32 s89, 0x358637bd
    s_mov_b32 s95, s28
    s_lshl_b32 s96, s26, 2
    v_mfma_f32_16x16x32_bf16 v[136:139], v[28:31], v[56:59], v[136:139]
    s_add_u32 m0, s72, 115712
    s_add_u32 s30, s30, 1
    buffer_load_dwordx4 v11, s[40:43], s66 offen lds
    s_cmp_eq_u32 s30, 7
    s_cselect_b32 s30, 0, s30
    v_mfma_f32_16x16x32_bf16 v[140:143], v[28:31], v[60:63], v[140:143]
    s_add_u32 s96, s96, s27
    v_add_u32 v64, 98304, v13
    v_add_u32 v65, 98304, v14
    s_waitcnt lgkmcnt(6)
    v_mfma_f32_32x32x16_bf16 v[72:87], v[232:235], v[240:243], v[72:87]
    v_mfma_f32_32x32x16_bf16 v[88:103], v[232:235], v[244:247], v[88:103]
    s_waitcnt lgkmcnt(0)
    s_waitcnt vmcnt(7)
    s_barrier
    ds_read_b128 v[48:51], v13 offset:49152
    ds_read_b64_tr_b16 v[56:57], v18 offset:0
    ds_read_b64_tr_b16 v[58:59], v18 offset:1024
    ds_read_b64_tr_b16 v[60:61], v18 offset:16384
    ds_read_b64_tr_b16 v[62:63], v18 offset:17408
    ds_read_b128 v[52:55], v13 offset:53248
    v_mfma_f32_32x32x16_bf16 v[104:119], v[236:239], v[240:243], v[104:119]
    s_add_u32 m0, s71, 0
    s_lshl_b32 s64, s30, 7
    buffer_load_dwordx4 v8, s[36:39], s64 offen lds
    v_mfma_f32_32x32x16_bf16 v[120:135], v[236:239], v[244:247], v[120:135]
    v_add_u32 v66, 98304, v15
    v_add_u32 v67, 98304, v16
    s_lshl_b32 s97, s92, 2
    v_mfma_f32_16x16x32_bf16 v[136:139], v[28:31], v[240:243], v[136:139]
    s_add_u32 m0, s71, 1024
    s_mul_i32 s65, s30, 172032
    buffer_load_dwordx4 v9, s[36:39], s64 offen lds
    v_mfma_f32_16x16x32_bf16 v[140:143], v[28:31], v[244:247], v[140:143]
    s_add_u32 s97, s97, s73
    s_add_u32 s35, s97, 24
    s_lshl_b32 s31, s35, 12
    v_mfma_f32_32x32x16_bf16 v[72:87], v[32:35], v[40:43], v[72:87]
    ds_read_b128 v[232:235], v14 offset:49152
    ds_read_b64_tr_b16 v[240:241], v18 offset:4096
    ds_read_b64_tr_b16 v[242:243], v18 offset:5120
    ds_read_b64_tr_b16 v[244:245], v18 offset:20480
    ds_read_b64_tr_b16 v[246:247], v18 offset:21504
    ds_read_b128 v[236:239], v14 offset:53248
    v_mfma_f32_32x32x16_bf16 v[88:103], v[32:35], v[44:47], v[88:103]
    v_mfma_f32_32x32x16_bf16 v[104:119], v[36:39], v[40:43], v[104:119]
    s_add_u32 m0, s72, 0
    s_add_u32 s66, s65, 896
    buffer_load_dwordx4 v10, s[40:43], s65 offen lds
    v_mfma_f32_32x32x16_bf16 v[120:135], v[36:39], v[44:47], v[120:135]
    s_add_u32 s31, s31, 98304
    v_add_u32 v21, s31, v1
    s_lshl_b32 s32, s75, 9
    v_mfma_f32_16x16x32_bf16 v[136:139], v[28:31], v[40:43], v[136:139]
    s_add_u32 m0, s72, 1024
    s_nop 0
    buffer_load_dwordx4 v11, s[40:43], s65 offen lds
    v_mfma_f32_16x16x32_bf16 v[140:143], v[28:31], v[44:47], v[140:143]
    v_add_u32 v4, s32, v21
    v_mov_b32 v5, 117440512
    v_cndmask_b32 v4, v4, v5, s[78:79]
    s_waitcnt lgkmcnt(6)
    v_mfma_f32_32x32x16_bf16 v[72:87], v[48:51], v[56:59], v[72:87]
    ds_read_b128 v[32:35], v15 offset:49152
    ds_read_b64_tr_b16 v[40:41], v18 offset:8192
    ds_read_b64_tr_b16 v[42:43], v18 offset:9216
    ds_read_b64_tr_b16 v[44:45], v18 offset:24576
    ds_read_b64_tr_b16 v[46:47], v18 offset:25600
    ds_read_b128 v[36:39], v15 offset:53248
    v_mfma_f32_32x32x16_bf16 v[88:103], v[48:51], v[60:63], v[88:103]
    s_add_u32 m0, s72, 16384
    s_nop 0
    buffer_load_dwordx4 v10, s[40:43], s66 offen lds
    v_mfma_f32_32x32x16_bf16 v[104:119], v[52:55], v[56:59], v[104:119]
    s_cmp_lt_u32 s29, 7
    s_cselect_b32 s32, s74, 1
    s_cmp_eq_u32 s32, 0
    s_cselect_b32 s32, 0, 117440512
    v_mfma_f32_32x32x16_bf16 v[120:135], v[52:55], v[60:63], v[120:135]
    s_add_u32 m0, s72, 17408
    s_add_u32 s30, s30, 1
    buffer_load_dwordx4 v11, s[40:43], s66 offen lds
    s_cmp_eq_u32 s30, 7
    s_cselect_b32 s30, 0, s30
    v_add_u32 v22, s32, v4
    s_waitcnt lgkmcnt(6)
    v_mfma_f32_32x32x16_bf16 v[72:87], v[232:235], v[240:243], v[72:87]
    ds_read_b128 v[48:51], v16 offset:49152
    ds_read_b64_tr_b16 v[56:57], v18 offset:12288
    ds_read_b64_tr_b16 v[58:59], v18 offset:13312
    ds_read_b64_tr_b16 v[60:61], v18 offset:28672
    ds_read_b64_tr_b16 v[62:63], v18 offset:29696
    ds_read_b128 v[52:55], v16 offset:53248
    v_mfma_f32_32x32x16_bf16 v[88:103], v[232:235], v[244:247], v[88:103]
    v_mov_b32 v188, v136
    v_mfma_f32_32x32x16_bf16 v[104:119], v[236:239], v[240:243], v[104:119]
    v_mov_b32 v189, v140
    v_mov_b32 v190, v248
    v_mfma_f32_32x32x16_bf16 v[120:135], v[236:239], v[244:247], v[120:135]
    v_mov_b32 v191, v248
    buffer_store_dwordx4 v[188:191], v22, s[52:55], 0 offen sc1
    s_waitcnt lgkmcnt(6)
    v_mfma_f32_32x32x16_bf16 v[72:87], v[32:35], v[40:43], v[72:87]
    v_mfma_f32_32x32x16_bf16 v[88:103], v[32:35], v[44:47], v[88:103]
    s_waitcnt lgkmcnt(0)
    s_waitcnt vmcnt(7)
    s_barrier
    ds_read_b128 v[232:235], v64 offset:0
    ds_read_b64_tr_b16 v[240:241], v19 offset:0
    ds_read_b64_tr_b16 v[242:243], v19 offset:1024
    ds_read_b64_tr_b16 v[244:245], v19 offset:16384
    ds_read_b64_tr_b16 v[246:247], v19 offset:17408
    ds_read_b128 v[236:239], v64 offset:4096
    v_mfma_f32_32x32x16_bf16 v[104:119], v[36:39], v[40:43], v[104:119]
    s_add_u32 m0, s71, 49152
    s_lshl_b32 s64, s30, 7
    buffer_load_dwordx4 v8, s[36:39], s64 offen lds
    s_lshl_b32 s31, s29, 11
    s_lshl_b32 s32, s74, 10
    s_add_u32 s31, s31, s32
    s_add_u32 s31, s31, 65536
    v_add_u32 v250, s31, v1
    s_and_b32 s31, s95, 0
    v_mfma_f32_32x32x16_bf16 v[120:135], v[36:39], v[44:47], v[120:135]
    s_add_u32 m0, s71, 50176
    s_mul_i32 s65, s30, 172032
    buffer_load_dwordx4 v9, s[36:39], s64 offen lds
    s_lshl_b32 s31, s31, 2
    s_xor_b32 s87, s3, s31
    s_mov_b32 s80, 0x3010200
    s_mov_b32 s81, 0x313230
    s_cmp_eq_u32 s87, 1
    s_cselect_b32 s80, 0x9070806, s80
    s_cselect_b32 s81, 0x373633, s81
    v_mfma_f32_32x32x16_bf16 v[72:87], v[48:51], v[56:59], v[72:87]
    ds_read_b128 v[32:35], v65 offset:0
    ds_read_b64_tr_b16 v[40:41], v19 offset:4096
    ds_read_b64_tr_b16 v[42:43], v19 offset:5120
    ds_read_b64_tr_b16 v[44:45], v19 offset:20480
    ds_read_b64_tr_b16 v[46:47], v19 offset:21504
    ds_read_b128 v[36:39], v65 offset:4096
    v_mfma_f32_32x32x16_bf16 v[88:103], v[48:51], v[60:63], v[88:103]
    s_add_u32 m0, s72, 49152
    s_add_u32 s66, s65, 896
    buffer_load_dwordx4 v10, s[40:43], s65 offen lds
    s_cmp_eq_u32 s87, 2
    s_cselect_b32 s80, 0xf0d0e0c, s80
    s_cselect_b32 s81, 0xa0504, s81
    v_mfma_f32_32x32x16_bf16 v[104:119], v[52:55], v[56:59], v[104:119]
    s_cmp_eq_u32 s87, 3
    s_cselect_b32 s80, 0x15131412, s80
    s_cselect_b32 s81, 0x11100b, s81
    s_cmp_eq_u32 s87, 4
    s_cselect_b32 s80, 0x1b191a18, s80
    s_cselect_b32 s81, 0x1c1716, s81
    s_add_u32 m0, s72, 50176
    s_nop 0
    buffer_load_dwordx4 v11, s[40:43], s65 offen lds
    v_mfma_f32_32x32x16_bf16 v[120:135], v[52:55], v[60:63], v[120:135]
    s_cmp_eq_u32 s87, 5
    s_cselect_b32 s80, 0x211f201e, s80
    s_cselect_b32 s81, 0x23221d, s81
    s_cmp_eq_u32 s87, 6
    s_cselect_b32 s80, 0x27252624, s80
    s_cselect_b32 s81, 0x2e2928, s81
    s_cmp_eq_u32 s87, 7
    s_cselect_b32 s80, 0x2d2b2c2a, s80
    s_cselect_b32 s81, 0x35342f, s81
    s_waitcnt lgkmcnt(6)
    v_mfma_f32_32x32x16_bf16 v[72:87], v[232:235], v[240:243], v[72:87]
    ds_read_b128 v[48:51], v66 offset:0
    ds_read_b64_tr_b16 v[56:57], v19 offset:8192
    ds_read_b64_tr_b16 v[58:59], v19 offset:9216
    ds_read_b64_tr_b16 v[60:61], v19 offset:24576
    ds_read_b64_tr_b16 v[62:63], v19 offset:25600
    ds_read_b128 v[52:55], v66 offset:4096
    v_mfma_f32_32x32x16_bf16 v[88:103], v[232:235], v[244:247], v[88:103]
    s_add_u32 m0, s72, 65536
    s_nop 0
    buffer_load_dwordx4 v10, s[40:43], s66 offen lds
    s_bfe_u32 s86, s81, 0x80010
    s_bfe_u32 s85, s81, 0x80008
    v_mfma_f32_32x32x16_bf16 v[104:119], v[236:239], v[240:243], v[104:119]
    s_bfe_u32 s84, s81, 0x80000
    s_bfe_u32 s83, s80, 0x80018
    s_bfe_u32 s82, s80, 0x80010
    s_bfe_u32 s81, s80, 0x80008
    s_add_u32 m0, s72, 66560
    s_add_u32 s30, s30, 1
    buffer_load_dwordx4 v11, s[40:43], s66 offen lds
    s_cmp_eq_u32 s30, 7
    s_cselect_b32 s30, 0, s30
    v_mfma_f32_32x32x16_bf16 v[120:135], v[236:239], v[244:247], v[120:135]
    s_bfe_u32 s80, s80, 0x80000
    s_mov_b32 s56, s16
    s_and_b32 s57, s17, 0xffff
    s_mov_b32 s58, 1605632
    s_mov_b32 s59, 0x20000
    s_cmp_eq_u32 s28, 7
    s_cselect_b32 s58, 0, s58
    s_waitcnt lgkmcnt(6)
    v_mfma_f32_32x32x16_bf16 v[72:87], v[32:35], v[40:43], v[72:87]
    ds_read_b128 v[232:235], v67 offset:0
    ds_read_b64_tr_b16 v[240:241], v19 offset:12288
    ds_read_b64_tr_b16 v[242:243], v19 offset:13312
    ds_read_b64_tr_b16 v[244:245], v19 offset:28672
    ds_read_b64_tr_b16 v[246:247], v19 offset:29696
    ds_read_b128 v[236:239], v67 offset:4096
    v_mfma_f32_32x32x16_bf16 v[88:103], v[32:35], v[44:47], v[88:103]
    v_lshrrev_b32 v4, 3, v0
    v_mul_u32_u24 v4, 896, v4
    v_bfe_u32 v5, v0, 4, 1
    v_lshlrev_b32 v5, 2, v5
    v_mfma_f32_32x32x16_bf16 v[104:119], v[36:39], v[40:43], v[104:119]
    v_and_b32 v6, 7, v0
    v_xor_b32 v5, v5, v6
    v_lshl_add_u32 v4, v5, 4, v4
    s_lshl_b32 s31, s95, 7
    v_mfma_f32_32x32x16_bf16 v[120:135], v[36:39], v[44:47], v[120:135]
    v_add_u32 v2, s31, v4
    v_add_u32 v3, 7168, v2
    s_mul_i32 s98, s3, 6144
    s_mov_b32 s22, 0x11410040
    s_waitcnt lgkmcnt(6)
    v_mfma_f32_32x32x16_bf16 v[72:87], v[48:51], v[56:59], v[72:87]
    v_mfma_f32_32x32x16_bf16 v[88:103], v[48:51], v[60:63], v[88:103]
    s_waitcnt lgkmcnt(0)
    s_waitcnt vmcnt(7)
    s_barrier
    ds_read_b128 v[32:35], v13 offset:0
    ds_read_b64_tr_b16 v[40:41], v17 offset:0
    ds_read_b64_tr_b16 v[42:43], v17 offset:1024
    ds_read_b64_tr_b16 v[44:45], v17 offset:16384
    ds_read_b64_tr_b16 v[46:47], v17 offset:17408
    ds_read_b128 v[36:39], v13 offset:4096
    v_mfma_f32_32x32x16_bf16 v[104:119], v[52:55], v[56:59], v[104:119]
    s_add_u32 m0, s71, 98304
    s_lshl_b32 s64, s30, 7
    buffer_load_dwordx4 v8, s[36:39], s64 offen lds
    s_mov_b32 s23, 0x33321312
    s_cmp_eq_u32 s87, 1
    s_cselect_b32 s22, 0x134910c2, s22
    s_cmp_eq_u32 s3, 1
    s_cselect_b32 s23, 0x14151433, s23
    s_cmp_eq_u32 s87, 2
    s_cselect_b32 s22, 0x22860144, s22
    v_mfma_f32_32x32x16_bf16 v[120:135], v[52:55], v[60:63], v[120:135]
    s_add_u32 m0, s71, 99328
    s_mul_i32 s65, s30, 172032
    buffer_load_dwordx4 v9, s[36:39], s64 offen lds
    s_cmp_eq_u32 s3, 2
    s_cselect_b32 s23, 0x16353415, s23
    s_cmp_eq_u32 s87, 3
    s_cselect_b32 s22, 0x259231c6, s22
    s_cmp_eq_u32 s3, 3
    s_cselect_b32 s23, 0x17161716, s23
    v_mfma_f32_32x32x16_bf16 v[72:87], v[232:235], v[240:243], v[72:87]
    ds_read_b128 v[48:51], v14 offset:0
    ds_read_b64_tr_b16 v[56:57], v17 offset:4096
    ds_read_b64_tr_b16 v[58:59], v17 offset:5120
    ds_read_b64_tr_b16 v[60:61], v17 offset:20480
    ds_read_b64_tr_b16 v[62:63], v17 offset:21504
    ds_read_b128 v[52:55], v14 offset:4096
    v_mfma_f32_32x32x16_bf16 v[88:103], v[232:235], v[244:247], v[88:103]
    s_add_u32 m0, s72, 98304
    s_add_u32 s66, s65, 896
    buffer_load_dwordx4 v10, s[40:43], s65 offen lds
    s_cmp_eq_u32 s87, 4
    s_cselect_b32 s22, 0x289e6248, s22
    s_cmp_eq_u32 s3, 4
    s_cselect_b32 s23, 0x73725352, s23
    v_mfma_f32_32x32x16_bf16 v[104:119], v[236:239], v[240:243], v[104:119]
    s_cmp_eq_u32 s87, 5
    s_cselect_b32 s22, 0x2baa92ca, s22
    s_add_u32 m0, s72, 99328
    s_nop 0
    buffer_load_dwordx4 v11, s[40:43], s65 offen lds
    s_cmp_eq_u32 s3, 5
    s_cselect_b32 s23, 0x54555473, s23
    v_mfma_f32_32x32x16_bf16 v[120:135], v[236:239], v[244:247], v[120:135]
    s_cmp_eq_u32 s87, 6
    s_cselect_b32 s22, 0x2eb6c34c, s22
    s_cmp_eq_u32 s3, 6
    s_cselect_b32 s23, 0x56757455, s23
    s_cmp_eq_u32 s87, 7
    s_cselect_b32 s22, 0x31c2f3ce, s22
    s_waitcnt lgkmcnt(6)
    v_mfma_f32_32x32x16_bf16 v[72:87], v[32:35], v[40:43], v[72:87]
    ds_read_b128 v[232:235], v15 offset:0
    ds_read_b64_tr_b16 v[240:241], v17 offset:8192
    ds_read_b64_tr_b16 v[242:243], v17 offset:9216
    ds_read_b64_tr_b16 v[244:245], v17 offset:24576
    ds_read_b64_tr_b16 v[246:247], v17 offset:25600
    ds_read_b128 v[236:239], v15 offset:4096
    v_mfma_f32_32x32x16_bf16 v[88:103], v[32:35], v[44:47], v[88:103]
    s_add_u32 m0, s72, 114688
    s_nop 0
    buffer_load_dwordx4 v10, s[40:43], s66 offen lds
    s_cmp_eq_u32 s3, 7
    s_cselect_b32 s23, 0x57565756, s23
    v_mfma_f32_32x32x16_bf16 v[104:119], v[36:39], v[40:43], v[104:119]
    v_and_b32 v4, 31, v0
    v_mul_u32_u24 v4, 6, v4
    v_lshrrev_b32 v5, 5, v0
    v_lshlrev_b32 v5, 6, v5
    s_add_u32 m0, s72, 115712
    s_add_u32 s30, s30, 1
    buffer_load_dwordx4 v11, s[40:43], s66 offen lds
    s_cmp_eq_u32 s30, 7
    s_cselect_b32 s30, 0, s30
    v_mfma_f32_32x32x16_bf16 v[120:135], v[36:39], v[44:47], v[120:135]
    v_bfe_u32 v6, s22, v4, 6
    v_add_u32 v6, v6, v5
    v_add_u32 v4, 12, v4
    v_bfe_u32 v7, s22, v4, 6
    v_add_u32 v7, v7, v5
    v_lshlrev_b32 v4, 3, v0
    s_waitcnt lgkmcnt(6)
    v_mfma_f32_32x32x16_bf16 v[72:87], v[48:51], v[56:59], v[72:87]
    ds_read_b128 v[32:35], v16 offset:0
    ds_read_b64_tr_b16 v[40:41], v17 offset:12288
    ds_read_b64_tr_b16 v[42:43], v17 offset:13312
    ds_read_b64_tr_b16 v[44:45], v17 offset:28672
    ds_read_b64_tr_b16 v[46:47], v17 offset:29696
    ds_read_b128 v[36:39], v16 offset:4096
    v_mfma_f32_32x32x16_bf16 v[88:103], v[48:51], v[60:63], v[88:103]
    v_bfe_u32 v4, s23, v4, 8
    s_mov_b32 s76, 0xf0
    s_mov_b32 s77, 0
    v_cndmask_b32 v7, v7, v4, s[76:77]
    s_lshl_b32 s31, s96, 14
    s_add_u32 s31, s31, 11534336
    v_mfma_f32_32x32x16_bf16 v[104:119], v[52:55], v[56:59], v[104:119]
    v_lshl_add_u32 v6, v6, 7, s31
    v_lshl_add_u32 v7, v7, 7, s31
    v_mov_b32 v5, 117440512
    s_mov_b32 s76, 3
    s_mov_b32 s77, 3
    v_cndmask_b32 v23, v5, v6, s[76:77]
    buffer_load_dwordx4 v[168:171], v250, s[52:55], 0 offen sc1
    v_mfma_f32_32x32x16_bf16 v[120:135], v[52:55], v[60:63], v[120:135]
    buffer_load_dwordx4 v[172:175], v21, s[52:55], 0 offen offset:0 sc1
    buffer_load_dwordx4 v[176:179], v21, s[52:55], 0 offen offset:1024 sc1
    buffer_load_dwordx4 v[180:183], v21, s[52:55], 0 offen offset:2048 sc1
    buffer_load_dwordx4 v[184:187], v21, s[52:55], 0 offen offset:3072 sc1
    s_waitcnt lgkmcnt(6)
    v_mfma_f32_32x32x16_bf16 v[72:87], v[232:235], v[240:243], v[72:87]
    v_mfma_f32_32x32x16_bf16 v[88:103], v[232:235], v[244:247], v[88:103]
    s_waitcnt lgkmcnt(0)
    s_waitcnt vmcnt(11)
    s_barrier
    ds_read_b128 v[48:51], v13 offset:49152
    ds_read_b64_tr_b16 v[56:57], v18 offset:0
    ds_read_b64_tr_b16 v[58:59], v18 offset:1024
    ds_read_b64_tr_b16 v[60:61], v18 offset:16384
    ds_read_b64_tr_b16 v[62:63], v18 offset:17408
    ds_read_b128 v[52:55], v13 offset:53248
    v_mfma_f32_32x32x16_bf16 v[104:119], v[236:239], v[240:243], v[104:119]
    s_add_u32 m0, s71, 0
    s_lshl_b32 s64, s30, 7
    buffer_load_dwordx4 v8, s[36:39], s64 offen lds
    s_mov_b32 s76, 0xf7
    s_mov_b32 s77, 7
    v_cndmask_b32 v252, v5, v7, s[76:77]
    s_mov_b32 s11, 117440512
    s_add_u32 s31, s71, 147456
    v_lshl_add_u32 v6, v0, 2, s31
    v_mfma_f32_32x32x16_bf16 v[120:135], v[236:239], v[244:247], v[120:135]
    s_add_u32 m0, s71, 1024
    s_mul_i32 s65, s30, 172032
    buffer_load_dwordx4 v9, s[36:39], s64 offen lds
    v_lshrrev_b32 v7, 5, v0
    v_lshl_add_u32 v7, v7, 4, s31
    v_mov_b32 v138, 0
    v_mov_b32 v139, 0
    v_mov_b32 v142, 0
    v_mov_b32 v143, 0
    v_mfma_f32_32x32x16_bf16 v[72:87], v[32:35], v[40:43], v[72:87]
    ds_read_b128 v[232:235], v14 offset:49152
    ds_read_b64_tr_b16 v[240:241], v18 offset:4096
    ds_read_b64_tr_b16 v[242:243], v18 offset:5120
    ds_read_b64_tr_b16 v[244:245], v18 offset:20480
    ds_read_b64_tr_b16 v[246:247], v18 offset:21504
    ds_read_b128 v[236:239], v14 offset:53248
    v_mfma_f32_32x32x16_bf16 v[88:103], v[32:35], v[44:47], v[88:103]
    s_add_u32 m0, s72, 0
    s_add_u32 s66, s65, 896
    buffer_load_dwordx4 v10, s[40:43], s65 offen lds
    v_mov_b32 v146, 0
    v_mov_b32 v147, 0
    v_mfma_f32_32x32x16_bf16 v[104:119], v[36:39], v[40:43], v[104:119]
    v_mov_b32 v150, 0
    v_mov_b32 v151, 0
    s_mov_b32 s90, 0x10000000
    s_mov_b32 s91, 0x10000000
    s_add_u32 m0, s72, 1024
    s_nop 0
    buffer_load_dwordx4 v11, s[40:43], s65 offen lds
    v_mfma_f32_32x32x16_bf16 v[120:135], v[36:39], v[44:47], v[120:135]
    s_lshl_b32 s31, s73, 12
    s_add_u32 s31, s31, 147456
    v_add_u32 v26, s31, v1
    s_lshl_b32 s10, s97, 4
    s_add_u32 s10, s10, s29
    s_lshl_b32 s10, s10, 12
    s_waitcnt lgkmcnt(6)
    v_mfma_f32_32x32x16_bf16 v[72:87], v[48:51], v[56:59], v[72:87]
    ds_read_b128 v[32:35], v15 offset:49152
    ds_read_b64_tr_b16 v[40:41], v18 offset:8192
    ds_read_b64_tr_b16 v[42:43], v18 offset:9216
    ds_read_b64_tr_b16 v[44:45], v18 offset:24576
    ds_read_b64_tr_b16 v[46:47], v18 offset:25600
    ds_read_b128 v[36:39], v15 offset:53248
    v_mfma_f32_32x32x16_bf16 v[88:103], v[48:51], v[60:63], v[88:103]
    s_add_u32 m0, s72, 16384
    s_nop 0
    buffer_load_dwordx4 v10, s[40:43], s66 offen lds
    s_add_u32 s10, s10, 1048576
    v_mov_b32 v27, 0xff
    v_mfma_f32_32x32x16_bf16 v[104:119], v[52:55], v[56:59], v[104:119]
    v_mov_b32 v12, 0x3f803f80
    s_bfe_u32 s68, s94, 0x80008
    s_bfe_u32 s69, s94, 0x80010
    s_lshr_b32 s70, s94, 24
    s_add_u32 m0, s72, 17408
    s_add_u32 s30, s30, 1
    buffer_load_dwordx4 v11, s[40:43], s66 offen lds
    s_cmp_eq_u32 s30, 7
    s_cselect_b32 s30, 0, s30
    v_mfma_f32_32x32x16_bf16 v[120:135], v[52:55], v[60:63], v[120:135]
    s_and_b32 s67, s94, 0xff
    s_and_b32 s31, s96, 1
    s_mul_i32 s31, s31, 7
    s_add_u32 s87, s31, s3
    s_lshr_b32 s31, s96, 1
    s_mul_i32 s31, s31, 28
    s_waitcnt lgkmcnt(6)
    v_mfma_f32_32x32x16_bf16 v[72:87], v[232:235], v[240:243], v[72:87]
    ds_read_b128 v[48:51], v16 offset:49152
    ds_read_b64_tr_b16 v[56:57], v18 offset:12288
    ds_read_b64_tr_b16 v[58:59], v18 offset:13312
    ds_read_b64_tr_b16 v[60:61], v18 offset:28672
    ds_read_b64_tr_b16 v[62:63], v18 offset:29696
    ds_read_b128 v[52:55], v16 offset:53248
    v_mfma_f32_32x32x16_bf16 v[88:103], v[232:235], v[244:247], v[88:103]
    v_lshrrev_b32 v4, 2, v0
    v_add_u32 v4, s31, v4
    v_mul_u32_u24 v4, 896, v4
    v_and_b32 v5, 3, v0
    v_mfma_f32_32x32x16_bf16 v[104:119], v[236:239], v[240:243], v[104:119]
    v_lshl_add_u32 v4, v5, 4, v4
    s_lshl_b32 s31, s87, 6
    v_add_u32 v68, s31, v4
    v_add_u32 v69, 14336, v68
    v_mfma_f32_32x32x16_bf16 v[120:135], v[236:239], v[244:247], v[120:135]
    s_mov_b32 s60, s8
    s_and_b32 s61, s9, 0xffff
    s_mov_b32 s62, 401408
    s_mov_b32 s63, 0x20000
    s_cmp_eq_u32 s28, 7
    s_cselect_b32 s62, s62, 0
    s_waitcnt lgkmcnt(6)
    v_mfma_f32_32x32x16_bf16 v[72:87], v[32:35], v[40:43], v[72:87]
    v_mfma_f32_32x32x16_bf16 v[88:103], v[32:35], v[44:47], v[88:103]
    s_waitcnt lgkmcnt(0)
    s_waitcnt vmcnt(11)
    s_barrier
    ds_read_b128 v[232:235], v64 offset:0
    ds_read_b64_tr_b16 v[240:241], v19 offset:0
    ds_read_b64_tr_b16 v[242:243], v19 offset:1024
    ds_read_b64_tr_b16 v[244:245], v19 offset:16384
    ds_read_b64_tr_b16 v[246:247], v19 offset:17408
    ds_read_b128 v[236:239], v64 offset:4096
    v_mfma_f32_32x32x16_bf16 v[104:119], v[36:39], v[40:43], v[104:119]
    s_add_u32 m0, s98, 49152
    s_mul_i32 s93, s80, 28672
    buffer_load_dwordx4 v2, s[56:59], s93 offen lds
    v_mfma_f32_32x32x16_bf16 v[120:135], v[36:39], v[44:47], v[120:135]
    s_add_u32 m0, s98, 50176
    s_nop 0
    buffer_load_dwordx4 v3, s[56:59], s93 offen lds
    v_mfma_f32_32x32x16_bf16 v[72:87], v[48:51], v[56:59], v[72:87]
    ds_read_b128 v[32:35], v65 offset:0
    ds_read_b64_tr_b16 v[40:41], v19 offset:4096
    ds_read_b64_tr_b16 v[42:43], v19 offset:5120
    ds_read_b64_tr_b16 v[44:45], v19 offset:20480
    ds_read_b64_tr_b16 v[46:47], v19 offset:21504
    ds_read_b128 v[36:39], v65 offset:4096
    v_mfma_f32_32x32x16_bf16 v[88:103], v[48:51], v[60:63], v[88:103]
    s_add_u32 m0, s98, 51200
    s_mul_i32 s93, s80, 28672
    s_add_u32 s93, s93, 14336
    buffer_load_dwordx4 v2, s[56:59], s93 offen lds
    s_waitcnt vmcnt(9)
    v_cndmask_b32 v187, v187, v248, s[78:79]
    v_xor_b32 v169, v248, v169
    v_bitop3_b32 v169, v169, v171, v248 bitop3:0xf6
    v_bitop3_b32 v169, v169, v175, v248 bitop3:0xf6
    v_bitop3_b32 v169, v169, v179, v248 bitop3:0xf6
    v_bitop3_b32 v169, v169, v183, v248 bitop3:0xf6
    v_bitop3_b32 v169, v169, v187, v248 bitop3:0xf6
    v_cmp_ne_u32 vcc, 0, v169
    s_nop 1
    s_cmp_lg_u64 vcc, 0
    s_cbranch_scc1 Lvs_22
Lvd_23:
    v_add_f32 v152, 0x3727c5ac, v170
    v_mfma_f32_32x32x16_bf16 v[104:119], v[52:55], v[56:59], v[104:119]
    v_rsq_f32 v152, v152
    s_add_u32 m0, s98, 52224
    s_nop 0
    buffer_load_dwordx4 v3, s[56:59], s93 offen lds
    v_cvt_pk_bf16_f32 v154, -v168, 0
    v_mfma_f32_32x32x16_bf16 v[120:135], v[52:55], v[60:63], v[120:135]
    v_mul_f32 v153, 0x3fb8aa3b, v152
    ds_write_b32 v6, v153
    v_cndmask_b32 v184, v184, 0, s[78:79]
    s_waitcnt lgkmcnt(7)
    v_mfma_f32_32x32x16_bf16 v[72:87], v[232:235], v[240:243], v[72:87]
    ds_read_b128 v[48:51], v66 offset:0
    ds_read_b64_tr_b16 v[56:57], v19 offset:8192
    ds_read_b64_tr_b16 v[58:59], v19 offset:9216
    ds_read_b64_tr_b16 v[60:61], v19 offset:24576
    ds_read_b64_tr_b16 v[62:63], v19 offset:25600
    ds_read_b128 v[52:55], v66 offset:4096
    v_mfma_f32_32x32x16_bf16 v[88:103], v[232:235], v[244:247], v[88:103]
    s_add_u32 m0, s98, 53248
    s_mul_i32 s93, s81, 28672
    buffer_load_dwordx4 v2, s[56:59], s93 offen lds
    v_cndmask_b32 v185, v185, 0, s[78:79]
    v_add_f32 v172, v172, v176
    v_mfma_f32_32x32x16_bf16 v[104:119], v[236:239], v[240:243], v[104:119]
    v_add_f32 v180, v180, v184
    s_add_u32 m0, s98, 54272
    s_nop 0
    buffer_load_dwordx4 v3, s[56:59], s93 offen lds
    v_add_f32 v173, v173, v177
    v_mfma_f32_32x32x16_bf16 v[120:135], v[236:239], v[244:247], v[120:135]
    v_add_f32 v181, v181, v185
    v_add_f32 v172, v172, v180
    v_add_f32 v173, v173, v181
    s_waitcnt lgkmcnt(7)
    v_mfma_f32_32x32x16_bf16 v[72:87], v[32:35], v[40:43], v[72:87]
    ds_read_b128 v[232:235], v67 offset:0
    ds_read_b64_tr_b16 v[240:241], v19 offset:12288
    ds_read_b64_tr_b16 v[242:243], v19 offset:13312
    ds_read_b64_tr_b16 v[244:245], v19 offset:28672
    ds_read_b64_tr_b16 v[246:247], v19 offset:29696
    ds_read_b128 v[236:239], v67 offset:4096
    v_mfma_f32_32x32x16_bf16 v[88:103], v[32:35], v[44:47], v[88:103]
    v_mov_b32 v176, v172
    v_mov_b32 v177, v173
    v_mfma_f32_32x32x16_bf16 v[104:119], v[36:39], v[40:43], v[104:119]
    v_permlane32_swap_b32 v172, v176
    v_permlane32_swap_b32 v173, v177
    v_mfma_f32_32x32x16_bf16 v[120:135], v[36:39], v[44:47], v[120:135]
    v_add_f32 v160, v172, v176
    v_add_f32 v161, v173, v177
    v_lshlrev_b32 v155, 16, v154
    s_waitcnt lgkmcnt(6)
    v_mfma_f32_32x32x16_bf16 v[72:87], v[48:51], v[56:59], v[72:87]
    v_mfma_f32_32x32x16_bf16 v[88:103], v[48:51], v[60:63], v[88:103]
    s_waitcnt lgkmcnt(0)
    s_waitcnt vmcnt(6)
    s_barrier
    ds_read_b128 v[32:35], v13 offset:0
    ds_read_b64_tr_b16 v[40:41], v17 offset:0
    ds_read_b64_tr_b16 v[42:43], v17 offset:1024
    ds_read_b64_tr_b16 v[44:45], v17 offset:16384
    ds_read_b64_tr_b16 v[46:47], v17 offset:17408
    ds_read_b128 v[36:39], v13 offset:4096
    v_mfma_f32_32x32x16_bf16 v[104:119], v[52:55], v[56:59], v[104:119]
    s_add_u32 m0, s98, 98304
    s_mul_i32 s93, s81, 28672
    s_add_u32 s93, s93, 14336
    buffer_load_dwordx4 v2, s[56:59], s93 offen lds
    v_sub_f32 v155, -v168, v155
    v_cvt_pk_bf16_f32 v157, -v168, v155
    v_cndmask_b32 v136, v157, 0, s[78:79]
    v_mfma_f32_32x32x16_bf16 v[120:135], v[52:55], v[60:63], v[120:135]
    s_add_u32 m0, s98, 99328
    s_nop 0
    buffer_load_dwordx4 v3, s[56:59], s93 offen lds
    v_cndmask_b32 v137, v154, 0, s[78:79]
    v_cndmask_b32 v140, 0, v157, s[78:79]
    v_cndmask_b32 v141, 0, v154, s[78:79]
    v_cvt_pk_bf16_f32 v144, v160, v160
    v_mfma_f32_32x32x16_bf16 v[72:87], v[232:235], v[240:243], v[72:87]
    ds_read_b128 v[48:51], v14 offset:0
    ds_read_b64_tr_b16 v[56:57], v17 offset:4096
    ds_read_b64_tr_b16 v[58:59], v17 offset:5120
    ds_read_b64_tr_b16 v[60:61], v17 offset:20480
    ds_read_b64_tr_b16 v[62:63], v17 offset:21504
    ds_read_b128 v[52:55], v14 offset:4096
    v_mfma_f32_32x32x16_bf16 v[88:103], v[232:235], v[244:247], v[88:103]
    s_add_u32 m0, s98, 100352
    s_mul_i32 s93, s82, 28672
    buffer_load_dwordx4 v2, s[56:59], s93 offen lds
    v_and_b32 v158, 0xffff0000, v144
    v_sub_f32 v158, v160, v158
    v_mfma_f32_32x32x16_bf16 v[104:119], v[236:239], v[240:243], v[104:119]
    v_cvt_pk_bf16_f32 v145, v158, 0
    s_add_u32 m0, s98, 101376
    s_nop 0
    buffer_load_dwordx4 v3, s[56:59], s93 offen lds
    v_cvt_pk_bf16_f32 v148, v161, v161
    v_mfma_f32_32x32x16_bf16 v[120:135], v[236:239], v[244:247], v[120:135]
    v_and_b32 v158, 0xffff0000, v148
    v_sub_f32 v158, v161, v158
    v_cvt_pk_bf16_f32 v149, v158, 0
    s_waitcnt lgkmcnt(6)
    v_mfma_f32_32x32x16_bf16 v[72:87], v[32:35], v[40:43], v[72:87]
    ds_read_b128 v[232:235], v15 offset:0
    ds_read_b64_tr_b16 v[240:241], v17 offset:8192
    ds_read_b64_tr_b16 v[242:243], v17 offset:9216
    ds_read_b64_tr_b16 v[244:245], v17 offset:24576
    ds_read_b64_tr_b16 v[246:247], v17 offset:25600
    ds_read_b128 v[236:239], v15 offset:4096
    v_mfma_f32_32x32x16_bf16 v[88:103], v[32:35], v[44:47], v[88:103]
    s_add_u32 m0, s98, 102400
    s_mul_i32 s93, s82, 28672
    s_add_u32 s93, s93, 14336
    buffer_load_dwordx4 v2, s[56:59], s93 offen lds
    ds_read_b128 v[176:179], v7 offset:0
    v_mfma_f32_32x32x16_bf16 v[104:119], v[36:39], v[40:43], v[104:119]
    ds_read_b128 v[180:183], v7 offset:32
    s_add_u32 m0, s98, 103424
    s_nop 0
    buffer_load_dwordx4 v3, s[56:59], s93 offen lds
    v_mfma_f32_32x32x16_bf16 v[120:135], v[36:39], v[44:47], v[120:135]
    ds_read_b128 v[184:187], v7 offset:64
    ds_read_b128 v[188:191], v7 offset:96
    s_waitcnt lgkmcnt(10)
    v_mfma_f32_32x32x16_bf16 v[72:87], v[48:51], v[56:59], v[72:87]
    ds_read_b128 v[32:35], v16 offset:0
    ds_read_b64_tr_b16 v[40:41], v17 offset:12288
    ds_read_b64_tr_b16 v[42:43], v17 offset:13312
    ds_read_b64_tr_b16 v[44:45], v17 offset:28672
    ds_read_b64_tr_b16 v[46:47], v17 offset:29696
    ds_read_b128 v[36:39], v16 offset:4096
    v_mfma_f32_32x32x16_bf16 v[88:103], v[48:51], v[60:63], v[88:103]
    ds_read_b128 v[192:195], v7 offset:128
    v_mfma_f32_32x32x16_bf16 v[104:119], v[52:55], v[56:59], v[104:119]
    ds_read_b128 v[196:199], v7 offset:160
    v_mfma_f32_32x32x16_bf16 v[120:135], v[52:55], v[60:63], v[120:135]
    ds_read_b128 v[200:203], v7 offset:192
    ds_read_b128 v[204:207], v7 offset:224
    s_waitcnt lgkmcnt(14)
    v_mfma_f32_32x32x16_bf16 v[72:87], v[232:235], v[240:243], v[72:87]
    v_mfma_f32_32x32x16_bf16 v[88:103], v[232:235], v[244:247], v[88:103]
    s_waitcnt lgkmcnt(0)
    s_barrier
    v_mfma_f32_32x32x16_bf16 v[104:119], v[236:239], v[240:243], v[104:119]
    v_lshrrev_b32 v4, 5, v0
    v_lshlrev_b32 v4, 2, v4
    v_bfe_u32 v5, v0, 2, 2
    v_mfma_f32_32x32x16_bf16 v[120:135], v[236:239], v[244:247], v[120:135]
    v_add_u32 v4, v4, v5
    v_lshlrev_b32 v4, 7, v4
    v_bfe_u32 v5, v0, 4, 1
    v_lshl_add_u32 v4, v5, 5, v4
    v_and_b32 v5, 3, v0
    v_lshl_add_u32 v4, v5, 3, v4
    v_mfma_f32_32x32x16_bf16 v[72:87], v[32:35], v[40:43], v[72:87]
    v_mfma_f32_32x32x16_bf16 v[88:103], v[32:35], v[44:47], v[88:103]
    v_bfe_u32 v5, v0, 3, 1
    v_lshl_add_u32 v4, v5, 6, v4
    v_add_u32 v6, s98, v4
    v_mfma_f32_32x32x16_bf16 v[104:119], v[36:39], v[40:43], v[104:119]
    v_xor_b32 v7, 64, v6
    v_add_u32 v8, 49152, v6
    v_add_u32 v9, 49152, v7
    v_mfma_f32_32x32x16_bf16 v[120:135], v[36:39], v[44:47], v[120:135]
    v_add_u32 v10, 98304, v6
    v_add_u32 v11, 98304, v7
    v_mfma_f32_32x32x16_bf16 v[72:87], v[136:139], v[144:147], v[72:87]
    v_mfma_f32_32x32x16_bf16 v[88:103], v[136:139], v[148:151], v[88:103]
    v_mfma_f32_32x32x16_bf16 v[104:119], v[140:143], v[144:147], v[104:119]
    v_mfma_f32_32x32x16_bf16 v[120:135], v[140:143], v[148:151], v[120:135]
    s_mov_b32 s76, 0x3f317218
    s_mov_b32 s77, 0x3f317218
    s_waitcnt vmcnt(0)
    ds_read_b64_tr_b16 v[208:209], v8 offset:0
    ds_read_b64_tr_b16 v[210:211], v8 offset:1024
    ds_read_b64_tr_b16 v[212:213], v9 offset:0
    ds_read_b64_tr_b16 v[214:215], v9 offset:1024
    ds_read_b64_tr_b16 v[216:217], v8 offset:2048
    ds_read_b64_tr_b16 v[218:219], v8 offset:3072
    ds_read_b64_tr_b16 v[220:221], v9 offset:2048
    ds_read_b64_tr_b16 v[222:223], v9 offset:3072
    ds_read_b64_tr_b16 v[224:225], v8 offset:4096
    ds_read_b64_tr_b16 v[226:227], v8 offset:5120
    ds_read_b64_tr_b16 v[228:229], v9 offset:4096
    ds_read_b64_tr_b16 v[230:231], v9 offset:5120
    ds_read_b64_tr_b16 v[232:233], v10 offset:0
    ds_read_b64_tr_b16 v[234:235], v10 offset:1024
    ds_read_b64_tr_b16 v[236:237], v11 offset:0
    ds_read_b64_tr_b16 v[238:239], v11 offset:1024
    ds_read_b64_tr_b16 v[240:241], v10 offset:2048
    ds_read_b64_tr_b16 v[242:243], v10 offset:3072
    ds_read_b64_tr_b16 v[244:245], v11 offset:2048
    ds_read_b64_tr_b16 v[246:247], v11 offset:3072
    s_cmp_eq_u32 s74, 0
    s_cbranch_scc1 Lkt_25
    s_cmp_eq_u32 s28, 7
    s_cbranch_scc1 Lkt_26
    s_add_u32 m0, s98, 0
    s_mul_i32 s93, s83, 28672
    buffer_load_dwordx4 v2, s[56:59], s93 offen lds
    s_add_u32 m0, s98, 1024
    s_nop 0
    buffer_load_dwordx4 v3, s[56:59], s93 offen lds
    s_add_u32 m0, s98, 2048
    s_mul_i32 s93, s83, 28672
    s_add_u32 s93, s93, 14336
    buffer_load_dwordx4 v2, s[56:59], s93 offen lds
    s_add_u32 m0, s98, 3072
    s_nop 0
    buffer_load_dwordx4 v3, s[56:59], s93 offen lds
    s_add_u32 m0, s98, 4096
    s_mul_i32 s93, s84, 28672
    buffer_load_dwordx4 v2, s[56:59], s93 offen lds
    s_add_u32 m0, s98, 5120
    s_nop 0
    buffer_load_dwordx4 v3, s[56:59], s93 offen lds
    s_waitcnt lgkmcnt(0)
    s_add_u32 m0, s98, 49152
    s_mul_i32 s93, s84, 28672
    s_add_u32 s93, s93, 14336
    buffer_load_dwordx4 v2, s[56:59], s93 offen lds
    s_add_u32 m0, s98, 50176
    s_nop 0
    buffer_load_dwordx4 v3, s[56:59], s93 offen lds
    s_add_u32 m0, s98, 51200
    s_mul_i32 s93, s85, 28672
    buffer_load_dwordx4 v2, s[56:59], s93 offen lds
    s_add_u32 m0, s98, 52224
    s_nop 0
    buffer_load_dwordx4 v3, s[56:59], s93 offen lds
    s_add_u32 m0, s98, 53248
    s_mul_i32 s93, s85, 28672
    s_add_u32 s93, s93, 14336
    buffer_load_dwordx4 v2, s[56:59], s93 offen lds
    s_add_u32 m0, s98, 54272
    s_nop 0
    buffer_load_dwordx4 v3, s[56:59], s93 offen lds
    s_add_u32 m0, s98, 98304
    s_mul_i32 s93, s86, 28672
    buffer_load_dwordx4 v2, s[56:59], s93 offen lds
    s_add_u32 m0, s98, 99328
    s_nop 0
    buffer_load_dwordx4 v3, s[56:59], s93 offen lds
    s_add_u32 m0, s98, 100352
    s_mul_i32 s93, s86, 28672
    s_add_u32 s93, s93, 14336
    buffer_load_dwordx4 v2, s[56:59], s93 offen lds
    s_add_u32 m0, s98, 101376
    s_nop 0
    buffer_load_dwordx4 v3, s[56:59], s93 offen lds
    s_branch Lkt_25
Lkt_26:
    s_mov_b32 m0, s71
    s_nop 0
    buffer_load_dwordx4 v68, s[60:63], 0 offen lds
    s_add_u32 m0, s71, 1024
    s_nop 0
    buffer_load_dwordx4 v69, s[60:63], 0 offen lds
Lkt_25:
    s_nop 7
    v_pk_mul_f32 v[72:73], v[72:73], v[176:177]
    v_pk_mul_f32 v[74:75], v[74:75], v[178:179]
    v_pk_mul_f32 v[76:77], v[76:77], v[180:181]
    v_pk_mul_f32 v[78:79], v[78:79], v[182:183]
    v_exp_f32 v32, v72 clamp
    v_exp_f32 v33, v73 clamp
    v_exp_f32 v34, v74 clamp
    v_exp_f32 v35, v75 clamp
    v_exp_f32 v36, v76 clamp
    v_exp_f32 v37, v77 clamp
    v_exp_f32 v38, v78 clamp
    v_exp_f32 v39, v79 clamp
    v_max_f32 v72, 0, v72
    v_max_f32 v73, 0, v73
    v_max_f32 v74, 0, v74
    v_max_f32 v75, 0, v75
    v_max_f32 v76, 0, v76
    v_max_f32 v77, 0, v77
    v_max_f32 v78, 0, v78
    v_max_f32 v79, 0, v79
    v_pk_add_f32 v[32:33], v[32:33], s[88:89]
    v_pk_add_f32 v[34:35], v[34:35], s[88:89]
    v_pk_add_f32 v[36:37], v[36:37], s[88:89]
    v_pk_add_f32 v[38:39], v[38:39], s[88:89]
    v_pk_fma_f32 v[32:33], v[72:73], s[76:77], v[32:33]
    v_pk_fma_f32 v[34:35], v[74:75], s[76:77], v[34:35]
    v_pk_fma_f32 v[36:37], v[76:77], s[76:77], v[36:37]
    v_pk_fma_f32 v[38:39], v[78:79], s[76:77], v[38:39]
    v_cvt_pk_bf16_f32 v48, v32, v33
    v_cvt_pk_bf16_f32 v49, v34, v35
    v_cvt_pk_bf16_f32 v50, v36, v37
    v_cvt_pk_bf16_f32 v51, v38, v39
    v_pk_mul_f32 v[80:81], v[80:81], v[184:185]
    v_pk_mul_f32 v[82:83], v[82:83], v[186:187]
    v_pk_mul_f32 v[84:85], v[84:85], v[188:189]
    v_pk_mul_f32 v[86:87], v[86:87], v[190:191]
    v_exp_f32 v40, v80 clamp
    v_exp_f32 v41, v81 clamp
    v_exp_f32 v42, v82 clamp
    v_exp_f32 v43, v83 clamp
    v_exp_f32 v44, v84 clamp
    v_exp_f32 v45, v85 clamp
    v_exp_f32 v46, v86 clamp
    v_exp_f32 v47, v87 clamp
    v_max_f32 v80, 0, v80
    v_max_f32 v81, 0, v81
    v_max_f32 v82, 0, v82
    v_max_f32 v83, 0, v83
    v_max_f32 v84, 0, v84
    v_max_f32 v85, 0, v85
    v_max_f32 v86, 0, v86
    v_max_f32 v87, 0, v87
    v_pk_add_f32 v[40:41], v[40:41], s[88:89]
    v_pk_add_f32 v[42:43], v[42:43], s[88:89]
    v_pk_add_f32 v[44:45], v[44:45], s[88:89]
    v_pk_add_f32 v[46:47], v[46:47], s[88:89]
    v_pk_fma_f32 v[40:41], v[80:81], s[76:77], v[40:41]
    v_pk_fma_f32 v[42:43], v[82:83], s[76:77], v[42:43]
    v_pk_fma_f32 v[44:45], v[84:85], s[76:77], v[44:45]
    v_pk_fma_f32 v[46:47], v[86:87], s[76:77], v[46:47]
    v_cvt_pk_bf16_f32 v52, v40, v41
    v_cvt_pk_bf16_f32 v53, v42, v43
    v_cvt_pk_bf16_f32 v54, v44, v45
    v_cvt_pk_bf16_f32 v55, v46, v47
    v_pk_mul_f32 v[88:89], v[88:89], v[176:177]
    v_pk_mul_f32 v[90:91], v[90:91], v[178:179]
    v_pk_mul_f32 v[92:93], v[92:93], v[180:181]
    v_pk_mul_f32 v[94:95], v[94:95], v[182:183]
    v_pk_mul_f32 v[96:97], v[96:97], v[184:185]
    v_pk_mul_f32 v[98:99], v[98:99], v[186:187]
    v_pk_mul_f32 v[100:101], v[100:101], v[188:189]
    v_pk_mul_f32 v[102:103], v[102:103], v[190:191]
    v_cvt_pk_bf16_f32 v56, v88, v89
    v_cvt_pk_bf16_f32 v57, v90, v91
    v_cvt_pk_bf16_f32 v58, v92, v93
    v_cvt_pk_bf16_f32 v59, v94, v95
    v_cvt_pk_bf16_f32 v60, v96, v97
    v_cvt_pk_bf16_f32 v61, v98, v99
    v_cvt_pk_bf16_f32 v62, v100, v101
    v_cvt_pk_bf16_f32 v63, v102, v103
    v_cndmask_b32 v56, v56, v12, s[90:91]
    v_cndmask_b32 v57, v57, v12, s[90:91]
    v_cndmask_b32 v58, v58, v12, s[90:91]
    v_cndmask_b32 v59, v59, v12, s[90:91]
    v_cndmask_b32 v60, v60, v12, s[90:91]
    v_cndmask_b32 v61, v61, v12, s[90:91]
    v_cndmask_b32 v62, v62, v12, s[90:91]
    v_cndmask_b32 v63, v63, v12, s[90:91]
    v_mfma_f32_32x32x16_bf16 v[160:175], v[56:59], v[48:51], 0
    s_nop 0
    v_mfma_f32_32x32x16_bf16 v[160:175], v[60:63], v[52:55], v[160:175]
    v_pk_mul_f32 v[104:105], v[104:105], v[192:193]
    v_pk_mul_f32 v[106:107], v[106:107], v[194:195]
    v_pk_mul_f32 v[108:109], v[108:109], v[196:197]
    v_pk_mul_f32 v[110:111], v[110:111], v[198:199]
    v_exp_f32 v32, v104 clamp
    v_exp_f32 v33, v105 clamp
    v_exp_f32 v34, v106 clamp
    v_exp_f32 v35, v107 clamp
    v_exp_f32 v36, v108 clamp
    v_exp_f32 v37, v109 clamp
    v_exp_f32 v38, v110 clamp
    v_exp_f32 v39, v111 clamp
    v_max_f32 v104, 0, v104
    v_max_f32 v105, 0, v105
    v_max_f32 v106, 0, v106
    v_max_f32 v107, 0, v107
    v_max_f32 v108, 0, v108
    v_max_f32 v109, 0, v109
    v_max_f32 v110, 0, v110
    v_max_f32 v111, 0, v111
    v_pk_add_f32 v[32:33], v[32:33], s[88:89]
    v_pk_add_f32 v[34:35], v[34:35], s[88:89]
    v_pk_add_f32 v[36:37], v[36:37], s[88:89]
    v_pk_add_f32 v[38:39], v[38:39], s[88:89]
    v_pk_fma_f32 v[32:33], v[104:105], s[76:77], v[32:33]
    v_pk_fma_f32 v[34:35], v[106:107], s[76:77], v[34:35]
    v_pk_fma_f32 v[36:37], v[108:109], s[76:77], v[36:37]
    v_pk_fma_f32 v[38:39], v[110:111], s[76:77], v[38:39]
    v_cvt_pk_bf16_f32 v48, v32, v33
    v_cvt_pk_bf16_f32 v49, v34, v35
    v_cvt_pk_bf16_f32 v50, v36, v37
    v_cvt_pk_bf16_f32 v51, v38, v39
    v_pk_mul_f32 v[112:113], v[112:113], v[200:201]
    v_pk_mul_f32 v[114:115], v[114:115], v[202:203]
    v_pk_mul_f32 v[116:117], v[116:117], v[204:205]
    v_pk_mul_f32 v[118:119], v[118:119], v[206:207]
    v_exp_f32 v40, v112 clamp
    v_exp_f32 v41, v113 clamp
    v_exp_f32 v42, v114 clamp
    v_exp_f32 v43, v115 clamp
    v_exp_f32 v44, v116 clamp
    v_exp_f32 v45, v117 clamp
    v_exp_f32 v46, v118 clamp
    v_exp_f32 v47, v119 clamp
    v_max_f32 v112, 0, v112
    v_max_f32 v113, 0, v113
    v_max_f32 v114, 0, v114
    v_max_f32 v115, 0, v115
    v_max_f32 v116, 0, v116
    v_max_f32 v117, 0, v117
    v_max_f32 v118, 0, v118
    v_max_f32 v119, 0, v119
    v_pk_add_f32 v[40:41], v[40:41], s[88:89]
    v_pk_add_f32 v[42:43], v[42:43], s[88:89]
    v_pk_add_f32 v[44:45], v[44:45], s[88:89]
    v_pk_add_f32 v[46:47], v[46:47], s[88:89]
    v_pk_fma_f32 v[40:41], v[112:113], s[76:77], v[40:41]
    v_pk_fma_f32 v[42:43], v[114:115], s[76:77], v[42:43]
    v_pk_fma_f32 v[44:45], v[116:117], s[76:77], v[44:45]
    v_pk_fma_f32 v[46:47], v[118:119], s[76:77], v[46:47]
    v_cvt_pk_bf16_f32 v52, v40, v41
    v_cvt_pk_bf16_f32 v53, v42, v43
    v_cvt_pk_bf16_f32 v54, v44, v45
    v_cvt_pk_bf16_f32 v55, v46, v47
    v_pk_mul_f32 v[120:121], v[120:121], v[192:193]
    v_pk_mul_f32 v[122:123], v[122:123], v[194:195]
    v_pk_mul_f32 v[124:125], v[124:125], v[196:197]
    v_pk_mul_f32 v[126:127], v[126:127], v[198:199]
    v_pk_mul_f32 v[128:129], v[128:129], v[200:201]
    v_pk_mul_f32 v[130:131], v[130:131], v[202:203]
    v_pk_mul_f32 v[132:133], v[132:133], v[204:205]
    v_pk_mul_f32 v[134:135], v[134:135], v[206:207]
    v_cvt_pk_bf16_f32 v56, v120, v121
    v_cvt_pk_bf16_f32 v57, v122, v123
    v_cvt_pk_bf16_f32 v58, v124, v125
    v_cvt_pk_bf16_f32 v59, v126, v127
    v_cvt_pk_bf16_f32 v60, v128, v129
    v_cvt_pk_bf16_f32 v61, v130, v131
    v_cvt_pk_bf16_f32 v62, v132, v133
    v_cvt_pk_bf16_f32 v63, v134, v135
    v_cndmask_b32 v56, v56, v12, s[90:91]
    v_cndmask_b32 v57, v57, v12, s[90:91]
    v_cndmask_b32 v58, v58, v12, s[90:91]
    v_cndmask_b32 v59, v59, v12, s[90:91]
    v_cndmask_b32 v60, v60, v12, s[90:91]
    v_cndmask_b32 v61, v61, v12, s[90:91]
    v_cndmask_b32 v62, v62, v12, s[90:91]
    v_cndmask_b32 v63, v63, v12, s[90:91]
    v_mfma_f32_32x32x16_bf16 v[160:175], v[56:59], v[48:51], v[160:175]
    s_nop 0
    v_mfma_f32_32x32x16_bf16 v[160:175], v[60:63], v[52:55], v[160:175]
    s_cmp_lg_u32 s74, 0
    s_cbranch_scc1 Lc_27
    s_nop 9
    ds_write_b128 v26, v[160:163] offset:0
    ds_write_b128 v26, v[164:167] offset:1024
    ds_write_b128 v26, v[168:171] offset:2048
    ds_write_b128 v26, v[172:175] offset:3072
    s_waitcnt lgkmcnt(0)
Lc_27:
    s_barrier
    s_cmp_eq_u32 s74, 0
    s_cbranch_scc1 Lc_28
    ds_read_b128 v[32:35], v26 offset:0
    ds_read_b128 v[36:39], v26 offset:1024
    ds_read_b128 v[40:43], v26 offset:2048
    ds_read_b128 v[44:47], v26 offset:3072
    s_nop 3
    s_waitcnt lgkmcnt(3)
    v_pk_add_f32 v[160:161], v[160:161], v[32:33]
    v_pk_add_f32 v[162:163], v[162:163], v[34:35]
    v_bfi_b32 v160, v27, s94, v160
    v_bfi_b32 v161, v27, s68, v161
    v_bfi_b32 v162, v27, s69, v162
    v_bfi_b32 v163, v27, s70, v163
    buffer_store_dwordx4 v[160:163], v1, s[52:55], s10 offen offset:0 sc1
    s_waitcnt lgkmcnt(2)
    v_pk_add_f32 v[164:165], v[164:165], v[36:37]
    v_pk_add_f32 v[166:167], v[166:167], v[38:39]
    v_bfi_b32 v164, v27, s94, v164
    v_bfi_b32 v165, v27, s68, v165
    v_bfi_b32 v166, v27, s69, v166
    v_bfi_b32 v167, v27, s70, v167
    buffer_store_dwordx4 v[164:167], v1, s[52:55], s10 offen offset:1024 sc1
    s_waitcnt lgkmcnt(1)
    v_pk_add_f32 v[168:169], v[168:169], v[40:41]
    v_pk_add_f32 v[170:171], v[170:171], v[42:43]
    v_bfi_b32 v168, v27, s94, v168
    v_bfi_b32 v169, v27, s68, v169
    v_bfi_b32 v170, v27, s69, v170
    v_bfi_b32 v171, v27, s70, v171
    buffer_store_dwordx4 v[168:171], v1, s[52:55], s10 offen offset:2048 sc1
    s_waitcnt lgkmcnt(0)
    v_pk_add_f32 v[172:173], v[172:173], v[44:45]
    v_pk_add_f32 v[174:175], v[174:175], v[46:47]
    v_bfi_b32 v172, v27, s94, v172
    v_bfi_b32 v173, v27, s68, v173
    v_bfi_b32 v174, v27, s69, v174
    v_bfi_b32 v175, v27, s70, v175
    buffer_store_dwordx4 v[172:175], v1, s[52:55], s10 offen offset:3072 sc1
Lc_28:
    s_barrier
    s_cmp_lg_u32 s74, 0
    s_cbranch_scc1 Lkt_29
    s_cmp_eq_u32 s28, 7
    s_cbranch_scc1 Lkt_30
    s_add_u32 m0, s98, 0
    s_mul_i32 s93, s83, 28672
    buffer_load_dwordx4 v2, s[56:59], s93 offen lds
    s_add_u32 m0, s98, 1024
    s_nop 0
    buffer_load_dwordx4 v3, s[56:59], s93 offen lds
    s_add_u32 m0, s98, 2048
    s_mul_i32 s93, s83, 28672
    s_add_u32 s93, s93, 14336
    buffer_load_dwordx4 v2, s[56:59], s93 offen lds
    s_add_u32 m0, s98, 3072
    s_nop 0
    buffer_load_dwordx4 v3, s[56:59], s93 offen lds
    s_add_u32 m0, s98, 4096
    s_mul_i32 s93, s84, 28672
    buffer_load_dwordx4 v2, s[56:59], s93 offen lds
    s_add_u32 m0, s98, 5120
    s_nop 0
    buffer_load_dwordx4 v3, s[56:59], s93 offen lds
    s_waitcnt lgkmcnt(0)
    s_add_u32 m0, s98, 49152
    s_mul_i32 s93, s84, 28672
    s_add_u32 s93, s93, 14336
    buffer_load_dwordx4 v2, s[56:59], s93 offen lds
    s_add_u32 m0, s98, 50176
    s_nop 0
    buffer_load_dwordx4 v3, s[56:59], s93 offen lds
    s_add_u32 m0, s98, 51200
    s_mul_i32 s93, s85, 28672
    buffer_load_dwordx4 v2, s[56:59], s93 offen lds
    s_add_u32 m0, s98, 52224
    s_nop 0
    buffer_load_dwordx4 v3, s[56:59], s93 offen lds
    s_add_u32 m0, s98, 53248
    s_mul_i32 s93, s85, 28672
    s_add_u32 s93, s93, 14336
    buffer_load_dwordx4 v2, s[56:59], s93 offen lds
    s_add_u32 m0, s98, 54272
    s_nop 0
    buffer_load_dwordx4 v3, s[56:59], s93 offen lds
    s_add_u32 m0, s98, 98304
    s_mul_i32 s93, s86, 28672
    buffer_load_dwordx4 v2, s[56:59], s93 offen lds
    s_add_u32 m0, s98, 99328
    s_nop 0
    buffer_load_dwordx4 v3, s[56:59], s93 offen lds
    s_add_u32 m0, s98, 100352
    s_mul_i32 s93, s86, 28672
    s_add_u32 s93, s93, 14336
    buffer_load_dwordx4 v2, s[56:59], s93 offen lds
    s_add_u32 m0, s98, 101376
    s_nop 0
    buffer_load_dwordx4 v3, s[56:59], s93 offen lds
    s_branch Lkt_29
Lkt_30:
    s_mov_b32 m0, s71
    s_nop 0
    buffer_load_dwordx4 v68, s[60:63], 0 offen lds
    s_add_u32 m0, s71, 1024
    s_nop 0
    buffer_load_dwordx4 v69, s[60:63], 0 offen lds
Lkt_29:
    s_cmp_eq_u32 s28, 7
    s_cbranch_scc1 Lred
    buffer_load_dword v24, v23, s[52:55], 0 offen sc1
    s_waitcnt lgkmcnt(0)
    s_mov_b32 s75, 1
    s_branch Lp2
Lred:
    s_lshr_b32 s22, s96, 1
    s_lshl_b32 s31, s22, 16
    s_lshl_b32 s32, s73, 10
    s_add_u32 s31, s31, s32
    s_add_u32 s31, s31, 1048576
    v_add_u32 v12, s31, v1
    s_lshl_b32 s32, s3, 11
    s_cmp_ge_u32 s3, 4
    s_cbranch_scc1 Lr_a
    s_mov_b32 s31, 0
    buffer_load_dwordx4 v[72:75], v12, s[52:55], s31 offen sc1
    s_mov_b32 s31, 4096
    buffer_load_dwordx4 v[76:79], v12, s[52:55], s31 offen sc1
    s_mov_b32 s31, 8192
    buffer_load_dwordx4 v[80:83], v12, s[52:55], s31 offen sc1
    s_mov_b32 s31, 12288
    buffer_load_dwordx4 v[84:87], v12, s[52:55], s31 offen sc1
    s_mov_b32 s31, 16384
    buffer_load_dwordx4 v[88:91], v12, s[52:55], s31 offen sc1
    s_mov_b32 s31, 20480
    buffer_load_dwordx4 v[92:95], v12, s[52:55], s31 offen sc1
    s_mov_b32 s31, 24576
    buffer_load_dwordx4 v[96:99], v12, s[52:55], s31 offen sc1
    s_mov_b32 s31, 28672
    buffer_load_dwordx4 v[100:103], v12, s[52:55], s31 offen sc1
    s_mov_b32 s31, 32768
    buffer_load_dwordx4 v[104:107], v12, s[52:55], s31 offen sc1
    s_mov_b32 s31, 36864
    buffer_load_dwordx4 v[108:111], v12, s[52:55], s31 offen sc1
    s_mov_b32 s31, 40960
    buffer_load_dwordx4 v[112:115], v12, s[52:55], s31 offen sc1
    s_mov_b32 s31, 45056
    buffer_load_dwordx4 v[116:119], v12, s[52:55], s31 offen sc1
    s_mov_b32 s31, 49152
    buffer_load_dwordx4 v[120:123], v12, s[52:55], s31 offen sc1
    s_mov_b32 s31, 53248
    buffer_load_dwordx4 v[124:127], v12, s[52:55], s31 offen sc1
    s_mov_b32 s31, 57344
    buffer_load_dwordx4 v[128:131], v12, s[52:55], s31 offen sc1
    s_mov_b32 s31, 61440
    buffer_load_dwordx4 v[132:135], v12, s[52:55], s31 offen sc1
Lr_a:
    v_lshrrev_b32 v6, 5, v0
    v_lshlrev_b32 v6, 2, v6
    v_bfe_u32 v7, v0, 2, 2
    v_add_u32 v6, v6, v7
    v_lshlrev_b32 v6, 6, v6
    v_bfe_u32 v7, v0, 4, 1
    v_lshl_add_u32 v6, v7, 5, v6
    v_and_b32 v7, 3, v0
    v_lshl_add_u32 v6, v7, 3, v6
    s_add_u32 s32, s32, 0
    v_add_u32 v14, s32, v6
    s_mov_b32 s90, 0
    s_cmp_eq_u32 s3, 3
    s_cselect_b32 s91, -1, 0
    s_lshl_b32 s11, s87, 11
    s_lshl_b32 s32, s22, 7
    s_add_u32 s11, s11, s32
    s_add_u32 s11, s11, 8192
    s_mul_i32 s23, s87, 28672
    s_mul_i32 s34, s22, 1792
    s_add_u32 s23, s23, s34
    s_add_u32 s23, s23, 262144
    s_cmp_eq_u32 s3, 7
    s_cselect_b32 s11, 117440512, s11
    s_cselect_b32 s23, 117440512, s23
    v_add_u32 v15, 65536, v1
    v_lshlrev_b32 v8, 3, v0
    v_mov_b32 v6, 117440512
    v_cndmask_b32 v9, v8, v6, s[78:79]
    s_add_u32 s32, s32, 4096
    v_and_b32 v4, 31, v0
    v_lshl_add_u32 v4, v4, 2, s32
    s_cmp_eq_u32 s87, 3
    s_mov_b32 vcc_lo, 0
    s_cselect_b32 vcc_hi, 0x55555555, 0
    v_cndmask_b32 v10, v6, v4, vcc
    s_lshr_b32 s34, s3, 1
    s_lshl_b32 s34, s34, 10
    s_and_b32 s32, s3, 1
    s_lshl_b32 s32, s32, 3
    s_add_u32 s34, s34, s32
    v_add_u32 v5, s34, v15
    v_mov_b32 v7, s94
    s_cmp_lt_u32 s3, 4
    s_cbranch_scc1 Lr_b
    s_waitcnt vmcnt(4)
Lr_b:
    s_waitcnt vmcnt(16)
    ds_read_b64_tr_b16 v[16:17], v14 offset:0
    ds_read_b64_tr_b16 v[18:19], v14 offset:512
    ds_read_b64_tr_b16 v[20:21], v14 offset:1024
    ds_read_b64_tr_b16 v[22:23], v14 offset:1536
    s_cmp_ge_u32 s3, 4
    s_cbranch_scc1 Lr_join
    s_movk_i32 s33, 20000
Lck_32:
    s_waitcnt vmcnt(12)
    v_xor_b32 v72, s67, v72
    v_xor_b32 v73, s68, v73
    v_xor_b32 v74, s69, v74
    v_xor_b32 v75, s70, v75
    v_xor_b32 v76, s67, v76
    v_xor_b32 v77, s68, v77
    v_xor_b32 v78, s69, v78
    v_xor_b32 v79, s70, v79
    v_xor_b32 v80, s67, v80
    v_xor_b32 v81, s68, v81
    v_xor_b32 v82, s69, v82
    v_xor_b32 v83, s70, v83
    v_xor_b32 v84, s67, v84
    v_xor_b32 v85, s68, v85
    v_xor_b32 v86, s69, v86
    v_xor_b32 v87, s70, v87
    v_or3_b32 v56, v72, v73, v74
    v_or3_b32 v57, v75, v76, v77
    v_or3_b32 v57, v57, v78, v79
    v_or3_b32 v56, v56, v80, v81
    v_or3_b32 v57, v57, v82, v83
    v_or3_b32 v56, v56, v84, v85
    v_or3_b32 v57, v57, v86, v87
    v_or_b32 v56, v56, v57
    v_and_b32 v56, 0xff, v56
    v_cmp_ne_u32 vcc, 0, v56
    s_nop 1
    s_cmp_lg_u64 vcc, 0
    s_cbranch_scc1 Lsl_33
Lbk_34:
    v_pk_add_f32 v[72:73], v[72:73], v[76:77]
    v_pk_add_f32 v[80:81], v[80:81], v[84:85]
    v_pk_add_f32 v[74:75], v[74:75], v[78:79]
    v_pk_add_f32 v[82:83], v[82:83], v[86:87]
    v_pk_add_f32 v[60:61], v[72:73], v[80:81]
    v_pk_add_f32 v[62:63], v[74:75], v[82:83]
    s_movk_i32 s33, 20000
Lck_35:
    s_waitcnt vmcnt(8)
    v_xor_b32 v88, s67, v88
    v_xor_b32 v89, s68, v89
    v_xor_b32 v90, s69, v90
    v_xor_b32 v91, s70, v91
    v_xor_b32 v92, s67, v92
    v_xor_b32 v93, s68, v93
    v_xor_b32 v94, s69, v94
    v_xor_b32 v95, s70, v95
    v_xor_b32 v96, s67, v96
    v_xor_b32 v97, s68, v97
    v_xor_b32 v98, s69, v98
    v_xor_b32 v99, s70, v99
    v_xor_b32 v100, s67, v100
    v_xor_b32 v101, s68, v101
    v_xor_b32 v102, s69, v102
    v_xor_b32 v103, s70, v103
    v_or3_b32 v56, v88, v89, v90
    v_or3_b32 v57, v91, v92, v93
    v_or3_b32 v57, v57, v94, v95
    v_or3_b32 v56, v56, v96, v97
    v_or3_b32 v57, v57, v98, v99
    v_or3_b32 v56, v56, v100, v101
    v_or3_b32 v57, v57, v102, v103
    v_or_b32 v56, v56, v57
    v_and_b32 v56, 0xff, v56
    v_cmp_ne_u32 vcc, 0, v56
    s_nop 1
    s_cmp_lg_u64 vcc, 0
    s_cbranch_scc1 Lsl_36
Lbk_37:
    v_pk_add_f32 v[88:89], v[88:89], v[92:93]
    v_pk_add_f32 v[96:97], v[96:97], v[100:101]
    v_pk_add_f32 v[90:91], v[90:91], v[94:95]
    v_pk_add_f32 v[98:99], v[98:99], v[102:103]
    v_pk_add_f32 v[88:89], v[88:89], v[96:97]
    v_pk_add_f32 v[90:91], v[90:91], v[98:99]
    v_pk_add_f32 v[60:61], v[60:61], v[88:89]
    v_pk_add_f32 v[62:63], v[62:63], v[90:91]
    s_movk_i32 s33, 20000
Lck_38:
    s_waitcnt vmcnt(4)
    v_xor_b32 v104, s67, v104
    v_xor_b32 v105, s68, v105
    v_xor_b32 v106, s69, v106
    v_xor_b32 v107, s70, v107
    v_xor_b32 v108, s67, v108
    v_xor_b32 v109, s68, v109
    v_xor_b32 v110, s69, v110
    v_xor_b32 v111, s70, v111
    v_xor_b32 v112, s67, v112
    v_xor_b32 v113, s68, v113
    v_xor_b32 v114, s69, v114
    v_xor_b32 v115, s70, v115
    v_xor_b32 v116, s67, v116
    v_xor_b32 v117, s68, v117
    v_xor_b32 v118, s69, v118
    v_xor_b32 v119, s70, v119
    v_or3_b32 v56, v104, v105, v106
    v_or3_b32 v57, v107, v108, v109
    v_or3_b32 v57, v57, v110, v111
    v_or3_b32 v56, v56, v112, v113
    v_or3_b32 v57, v57, v114, v115
    v_or3_b32 v56, v56, v116, v117
    v_or3_b32 v57, v57, v118, v119
    v_or_b32 v56, v56, v57
    v_and_b32 v56, 0xff, v56
    v_cmp_ne_u32 vcc, 0, v56
    s_nop 1
    s_cmp_lg_u64 vcc, 0
    s_cbranch_scc1 Lsl_39
Lbk_40:
    v_pk_add_f32 v[104:105], v[104:105], v[108:109]
    v_pk_add_f32 v[112:113], v[112:113], v[116:117]
    v_pk_add_f32 v[106:107], v[106:107], v[110:111]
    v_pk_add_f32 v[114:115], v[114:115], v[118:119]
    v_pk_add_f32 v[104:105], v[104:105], v[112:113]
    v_pk_add_f32 v[106:107], v[106:107], v[114:115]
    v_pk_add_f32 v[60:61], v[60:61], v[104:105]
    v_pk_add_f32 v[62:63], v[62:63], v[106:107]
    s_movk_i32 s33, 20000
Lck_41:
    s_waitcnt vmcnt(0)
    v_xor_b32 v120, s67, v120
    v_xor_b32 v121, s68, v121
    v_xor_b32 v122, s69, v122
    v_xor_b32 v123, s70, v123
    v_xor_b32 v124, s67, v124
    v_xor_b32 v125, s68, v125
    v_xor_b32 v126, s69, v126
    v_xor_b32 v127, s70, v127
    v_xor_b32 v128, s67, v128
    v_xor_b32 v129, s68, v129
    v_xor_b32 v130, s69, v130
    v_xor_b32 v131, s70, v131
    v_xor_b32 v132, s67, v132
    v_xor_b32 v133, s68, v133
    v_xor_b32 v134, s69, v134
    v_xor_b32 v135, s70, v135
    v_or3_b32 v56, v120, v121, v122
    v_or3_b32 v57, v123, v124, v125
    v_or3_b32 v57, v57, v126, v127
    v_or3_b32 v56, v56, v128, v129
    v_or3_b32 v57, v57, v130, v131
    v_or3_b32 v56, v56, v132, v133
    v_or3_b32 v57, v57, v134, v135
    v_or_b32 v56, v56, v57
    v_and_b32 v56, 0xff, v56
    v_cmp_ne_u32 vcc, 0, v56
    s_nop 1
    s_cmp_lg_u64 vcc, 0
    s_cbranch_scc1 Lsl_42
Lbk_43:
    v_pk_add_f32 v[120:121], v[120:121], v[124:125]
    v_pk_add_f32 v[128:129], v[128:129], v[132:133]
    v_pk_add_f32 v[122:123], v[122:123], v[126:127]
    v_pk_add_f32 v[130:131], v[130:131], v[134:135]
    v_pk_add_f32 v[120:121], v[120:121], v[128:129]
    v_pk_add_f32 v[122:123], v[122:123], v[130:131]
    v_pk_add_f32 v[60:61], v[60:61], v[120:121]
    v_pk_add_f32 v[62:63], v[62:63], v[122:123]
    v_pk_mul_f32 v[56:57], v[60:61], s[76:77]
    v_pk_mul_f32 v[58:59], v[62:63], s[76:77]
    v_mov_b32_dpp v6, v60 quad_perm:[1,1,3,3] row_mask:0xf bank_mask:0xf
    v_cvt_pk_bf16_f32 v12, v56, v57
    v_cvt_pk_bf16_f32 v13, v58, v59
    v_cndmask_b32 v12, v12, 0, s[90:91]
    v_cndmask_b32 v13, v13, 0, s[90:91]
    ds_write_b64 v5, v[12:13]
    v_cvt_pk_bf16_f32 v6, v60, v6
    buffer_store_dwordx2 v[6:7], v10, s[52:55], 0 offen sc1
Lr_join:
    s_waitcnt lgkmcnt(0)
    s_barrier
    ds_read_b128 v[32:35], v15
    ds_read_b128 v[36:39], v15 offset:1024
    s_waitcnt lgkmcnt(1)
    v_mfma_f32_32x32x16_bf16 v[96:111], v[32:35], v[16:19], 0
    s_waitcnt lgkmcnt(0)
    v_mfma_f32_32x32x16_bf16 v[96:111], v[36:39], v[20:23], v[96:111]
    s_nop 11
    v_cvt_pk_bf16_f32 v112, v96, v97
    v_cvt_pk_bf16_f32 v113, v98, v99
    buffer_store_dwordx2 v[112:113], v8, s[52:55], s23 offen offset:0 sc1
    v_cvt_pk_bf16_f32 v114, v100, v101
    v_cvt_pk_bf16_f32 v115, v102, v103
    buffer_store_dwordx2 v[114:115], v8, s[52:55], s23 offen offset:512 sc1
    v_cvt_pk_bf16_f32 v116, v104, v105
    v_cvt_pk_bf16_f32 v117, v106, v107
    buffer_store_dwordx2 v[116:117], v8, s[52:55], s23 offen offset:1024 sc1
    v_cvt_pk_bf16_f32 v118, v108, v109
    v_cvt_pk_bf16_f32 v119, v110, v111
    buffer_store_dwordx2 v[118:119], v9, s[52:55], s23 offen offset:1536 sc1
    s_waitcnt vmcnt(0)
    buffer_store_dword v248, v249, s[52:55], s11 offen sc1
    s_endpgm
Lvs_4:
    s_movk_i32 s33, 20000
Lvc_6:
    buffer_load_dwordx4 v[208:211], v250, s[52:55], 0 offen sc1
    buffer_load_dwordx4 v[212:215], v21, s[52:55], 0 offen offset:0 sc1
    buffer_load_dwordx4 v[216:219], v21, s[52:55], 0 offen offset:1024 sc1
    buffer_load_dwordx4 v[220:223], v21, s[52:55], 0 offen offset:2048 sc1
    buffer_load_dwordx4 v[224:227], v21, s[52:55], 0 offen offset:3072 sc1
    s_waitcnt vmcnt(0)
    v_cndmask_b32 v227, v227, v248, s[78:79]
    v_xor_b32 v209, v248, v209
    v_bitop3_b32 v209, v209, v211, v248 bitop3:0xf6
    v_bitop3_b32 v209, v209, v215, v248 bitop3:0xf6
    v_bitop3_b32 v209, v209, v219, v248 bitop3:0xf6
    v_bitop3_b32 v209, v209, v223, v248 bitop3:0xf6
    v_bitop3_b32 v209, v209, v227, v248 bitop3:0xf6
    v_cmp_ne_u32 vcc, 0, v209
    s_nop 1
    s_cmp_lg_u64 vcc, 0
    s_cbranch_scc0 Lvd_5
    s_sub_u32 s33, s33, 1
    s_cbranch_scc1 Lvd_5
    s_sleep 4
    s_branch Lvc_6
Lphi0:
    s_nop 7
    v_pk_mul_f32 v[32:33], v[64:65], v[54:55] op_sel_hi:[1,0]
    v_pk_mul_f32 v[34:35], v[66:67], v[54:55] op_sel_hi:[1,0]
    v_pk_mul_f32 v[36:37], v[68:69], v[54:55] op_sel_hi:[1,0]
    v_pk_mul_f32 v[38:39], v[70:71], v[54:55] op_sel_hi:[1,0]
    v_pk_fma_f32 v[64:65], v[64:65], v[52:53], s[88:89] op_sel_hi:[1,0,0]
    v_pk_fma_f32 v[66:67], v[66:67], v[52:53], s[88:89] op_sel_hi:[1,0,0]
    v_pk_fma_f32 v[68:69], v[68:69], v[52:53], s[88:89] op_sel_hi:[1,0,0]
    v_pk_fma_f32 v[70:71], v[70:71], v[52:53], s[88:89] op_sel_hi:[1,0,0]
    v_exp_f32 v32, v32 clamp
    v_exp_f32 v33, v33 clamp
    v_exp_f32 v34, v34 clamp
    v_exp_f32 v35, v35 clamp
    v_exp_f32 v36, v36 clamp
    v_exp_f32 v37, v37 clamp
    v_exp_f32 v38, v38 clamp
    v_exp_f32 v39, v39 clamp
    v_max_f32 v64, s88, v64
    v_max_f32 v65, s88, v65
    v_max_f32 v66, s88, v66
    v_max_f32 v67, s88, v67
    v_max_f32 v68, s88, v68
    v_max_f32 v69, s88, v69
    v_max_f32 v70, s88, v70
    v_max_f32 v71, s88, v71
    v_pk_add_f32 v[32:33], v[32:33], v[64:65]
    v_pk_add_f32 v[34:35], v[34:35], v[66:67]
    v_pk_add_f32 v[36:37], v[36:37], v[68:69]
    v_pk_add_f32 v[38:39], v[38:39], v[70:71]
    v_cvt_pk_bf16_f32 v208, v32, v33
    v_cvt_pk_bf16_f32 v209, v34, v35
    v_cvt_pk_bf16_f32 v210, v36, v37
    v_cvt_pk_bf16_f32 v211, v38, v39
    buffer_store_dwordx4 v[208:211], v1, s[52:55], s10 offen offset:0 sc1
    v_pk_mul_f32 v[40:41], v[72:73], v[54:55] op_sel_hi:[1,0]
    v_pk_mul_f32 v[42:43], v[74:75], v[54:55] op_sel_hi:[1,0]
    v_pk_mul_f32 v[44:45], v[76:77], v[54:55] op_sel_hi:[1,0]
    v_pk_mul_f32 v[46:47], v[78:79], v[54:55] op_sel_hi:[1,0]
    v_pk_fma_f32 v[72:73], v[72:73], v[52:53], s[88:89] op_sel_hi:[1,0,0]
    v_pk_fma_f32 v[74:75], v[74:75], v[52:53], s[88:89] op_sel_hi:[1,0,0]
    v_pk_fma_f32 v[76:77], v[76:77], v[52:53], s[88:89] op_sel_hi:[1,0,0]
    v_pk_fma_f32 v[78:79], v[78:79], v[52:53], s[88:89] op_sel_hi:[1,0,0]
    v_exp_f32 v40, v40 clamp
    v_exp_f32 v41, v41 clamp
    v_exp_f32 v42, v42 clamp
    v_exp_f32 v43, v43 clamp
    v_exp_f32 v44, v44 clamp
    v_exp_f32 v45, v45 clamp
    v_exp_f32 v46, v46 clamp
    v_exp_f32 v47, v47 clamp
    v_max_f32 v72, s88, v72
    v_max_f32 v73, s88, v73
    v_max_f32 v74, s88, v74
    v_max_f32 v75, s88, v75
    v_max_f32 v76, s88, v76
    v_max_f32 v77, s88, v77
    v_max_f32 v78, s88, v78
    v_max_f32 v79, s88, v79
    v_pk_add_f32 v[40:41], v[40:41], v[72:73]
    v_pk_add_f32 v[42:43], v[42:43], v[74:75]
    v_pk_add_f32 v[44:45], v[44:45], v[76:77]
    v_pk_add_f32 v[46:47], v[46:47], v[78:79]
    v_cvt_pk_bf16_f32 v212, v40, v41
    v_cvt_pk_bf16_f32 v213, v42, v43
    v_cvt_pk_bf16_f32 v214, v44, v45
    v_cvt_pk_bf16_f32 v215, v46, v47
    buffer_store_dwordx4 v[212:215], v1, s[52:55], s10 offen offset:1024 sc1
    s_add_u32 s10, s10, 4096
Lphi1:
    v_pk_mul_f32 v[32:33], v[80:81], v[54:55] op_sel_hi:[1,0]
    v_pk_mul_f32 v[34:35], v[82:83], v[54:55] op_sel_hi:[1,0]
    v_pk_mul_f32 v[36:37], v[84:85], v[54:55] op_sel_hi:[1,0]
    v_pk_mul_f32 v[38:39], v[86:87], v[54:55] op_sel_hi:[1,0]
    v_pk_fma_f32 v[80:81], v[80:81], v[52:53], s[88:89] op_sel_hi:[1,0,0]
    v_pk_fma_f32 v[82:83], v[82:83], v[52:53], s[88:89] op_sel_hi:[1,0,0]
    v_pk_fma_f32 v[84:85], v[84:85], v[52:53], s[88:89] op_sel_hi:[1,0,0]
    v_pk_fma_f32 v[86:87], v[86:87], v[52:53], s[88:89] op_sel_hi:[1,0,0]
    v_exp_f32 v32, v32 clamp
    v_exp_f32 v33, v33 clamp
    v_exp_f32 v34, v34 clamp
    v_exp_f32 v35, v35 clamp
    v_exp_f32 v36, v36 clamp
    v_exp_f32 v37, v37 clamp
    v_exp_f32 v38, v38 clamp
    v_exp_f32 v39, v39 clamp
    v_max_f32 v80, s88, v80
    v_max_f32 v81, s88, v81
    v_max_f32 v82, s88, v82
    v_max_f32 v83, s88, v83
    v_max_f32 v84, s88, v84
    v_max_f32 v85, s88, v85
    v_max_f32 v86, s88, v86
    v_max_f32 v87, s88, v87
    v_pk_add_f32 v[32:33], v[32:33], v[80:81]
    v_pk_add_f32 v[34:35], v[34:35], v[82:83]
    v_pk_add_f32 v[36:37], v[36:37], v[84:85]
    v_pk_add_f32 v[38:39], v[38:39], v[86:87]
    v_cvt_pk_bf16_f32 v216, v32, v33
    v_cvt_pk_bf16_f32 v217, v34, v35
    v_cvt_pk_bf16_f32 v218, v36, v37
    v_cvt_pk_bf16_f32 v219, v38, v39
    buffer_store_dwordx4 v[216:219], v1, s[52:55], s10 offen offset:0 sc1
    v_pk_mul_f32 v[40:41], v[88:89], v[54:55] op_sel_hi:[1,0]
    v_pk_mul_f32 v[42:43], v[90:91], v[54:55] op_sel_hi:[1,0]
    v_pk_mul_f32 v[44:45], v[92:93], v[54:55] op_sel_hi:[1,0]
    v_pk_mul_f32 v[46:47], v[94:95], v[54:55] op_sel_hi:[1,0]
    v_pk_fma_f32 v[88:89], v[88:89], v[52:53], s[88:89] op_sel_hi:[1,0,0]
    v_pk_fma_f32 v[90:91], v[90:91], v[52:53], s[88:89] op_sel_hi:[1,0,0]
    v_pk_fma_f32 v[92:93], v[92:93], v[52:53], s[88:89] op_sel_hi:[1,0,0]
    v_pk_fma_f32 v[94:95], v[94:95], v[52:53], s[88:89] op_sel_hi:[1,0,0]
    v_exp_f32 v40, v40 clamp
    v_exp_f32 v41, v41 clamp
    v_exp_f32 v42, v42 clamp
    v_exp_f32 v43, v43 clamp
    v_exp_f32 v44, v44 clamp
    v_exp_f32 v45, v45 clamp
    v_exp_f32 v46, v46 clamp
    v_exp_f32 v47, v47 clamp
    v_max_f32 v88, s88, v88
    v_max_f32 v89, s88, v89
    v_max_f32 v90, s88, v90
    v_max_f32 v91, s88, v91
    v_max_f32 v92, s88, v92
    v_max_f32 v93, s88, v93
    v_max_f32 v94, s88, v94
    v_max_f32 v95, s88, v95
    v_pk_add_f32 v[40:41], v[40:41], v[88:89]
    v_pk_add_f32 v[42:43], v[42:43], v[90:91]
    v_pk_add_f32 v[44:45], v[44:45], v[92:93]
    v_pk_add_f32 v[46:47], v[46:47], v[94:95]
    v_cvt_pk_bf16_f32 v220, v40, v41
    v_cvt_pk_bf16_f32 v221, v42, v43
    v_cvt_pk_bf16_f32 v222, v44, v45
    v_cvt_pk_bf16_f32 v223, v46, v47
    buffer_store_dwordx4 v[220:223], v1, s[52:55], s10 offen offset:1024 sc1
    s_add_u32 s10, s10, 4096
    s_branch Lepi1
Lphi2:
    v_pk_mul_f32 v[32:33], v[64:65], v[54:55] op_sel_hi:[1,0]
    v_pk_mul_f32 v[34:35], v[66:67], v[54:55] op_sel_hi:[1,0]
    v_pk_mul_f32 v[36:37], v[68:69], v[54:55] op_sel_hi:[1,0]
    v_pk_mul_f32 v[38:39], v[70:71], v[54:55] op_sel_hi:[1,0]
    v_pk_fma_f32 v[64:65], v[64:65], v[52:53], s[88:89] op_sel_hi:[1,0,0]
    v_pk_fma_f32 v[66:67], v[66:67], v[52:53], s[88:89] op_sel_hi:[1,0,0]
    v_pk_fma_f32 v[68:69], v[68:69], v[52:53], s[88:89] op_sel_hi:[1,0,0]
    v_pk_fma_f32 v[70:71], v[70:71], v[52:53], s[88:89] op_sel_hi:[1,0,0]
    v_exp_f32 v32, v32 clamp
    v_exp_f32 v33, v33 clamp
    v_exp_f32 v34, v34 clamp
    v_exp_f32 v35, v35 clamp
    v_exp_f32 v36, v36 clamp
    v_exp_f32 v37, v37 clamp
    v_exp_f32 v38, v38 clamp
    v_exp_f32 v39, v39 clamp
    v_max_f32 v64, s88, v64
    v_max_f32 v65, s88, v65
    v_max_f32 v66, s88, v66
    v_max_f32 v67, s88, v67
    v_max_f32 v68, s88, v68
    v_max_f32 v69, s88, v69
    v_max_f32 v70, s88, v70
    v_max_f32 v71, s88, v71
    v_pk_add_f32 v[32:33], v[32:33], v[64:65]
    v_pk_add_f32 v[34:35], v[34:35], v[66:67]
    v_pk_add_f32 v[36:37], v[36:37], v[68:69]
    v_pk_add_f32 v[38:39], v[38:39], v[70:71]
    v_cvt_pk_bf16_f32 v80, v32, v33
    v_cvt_pk_bf16_f32 v81, v34, v35
    v_cvt_pk_bf16_f32 v82, v36, v37
    v_cvt_pk_bf16_f32 v83, v38, v39
    s_waitcnt vmcnt(0)
    buffer_store_dwordx4 v[80:83], v1, s[52:55], s10 offen offset:0 sc1
    v_pk_mul_f32 v[40:41], v[72:73], v[54:55] op_sel_hi:[1,0]
    v_pk_mul_f32 v[42:43], v[74:75], v[54:55] op_sel_hi:[1,0]
    v_pk_mul_f32 v[44:45], v[76:77], v[54:55] op_sel_hi:[1,0]
    v_pk_mul_f32 v[46:47], v[78:79], v[54:55] op_sel_hi:[1,0]
    v_pk_fma_f32 v[72:73], v[72:73], v[52:53], s[88:89] op_sel_hi:[1,0,0]
    v_pk_fma_f32 v[74:75], v[74:75], v[52:53], s[88:89] op_sel_hi:[1,0,0]
    v_pk_fma_f32 v[76:77], v[76:77], v[52:53], s[88:89] op_sel_hi:[1,0,0]
    v_pk_fma_f32 v[78:79], v[78:79], v[52:53], s[88:89] op_sel_hi:[1,0,0]
    v_exp_f32 v40, v40 clamp
    v_exp_f32 v41, v41 clamp
    v_exp_f32 v42, v42 clamp
    v_exp_f32 v43, v43 clamp
    v_exp_f32 v44, v44 clamp
    v_exp_f32 v45, v45 clamp
    v_exp_f32 v46, v46 clamp
    v_exp_f32 v47, v47 clamp
    v_max_f32 v72, s88, v72
    v_max_f32 v73, s88, v73
    v_max_f32 v74, s88, v74
    v_max_f32 v75, s88, v75
    v_max_f32 v76, s88, v76
    v_max_f32 v77, s88, v77
    v_max_f32 v78, s88, v78
    v_max_f32 v79, s88, v79
    v_pk_add_f32 v[40:41], v[40:41], v[72:73]
    v_pk_add_f32 v[42:43], v[42:43], v[74:75]
    v_pk_add_f32 v[44:45], v[44:45], v[76:77]
    v_pk_add_f32 v[46:47], v[46:47], v[78:79]
    v_cvt_pk_bf16_f32 v84, v40, v41
    v_cvt_pk_bf16_f32 v85, v42, v43
    v_cvt_pk_bf16_f32 v86, v44, v45
    v_cvt_pk_bf16_f32 v87, v46, v47
    buffer_store_dwordx4 v[84:87], v1, s[52:55], s10 offen offset:1024 sc1
    s_add_u32 s10, s10, 4096
    s_branch Lp2
Lvs_7:
    s_movk_i32 s33, 20000
Lvc_9:
    buffer_load_dword v24, v23, s[52:55], 0 offen sc1
    s_waitcnt vmcnt(0)
    v_cmp_ne_u32 vcc, s94, v24
    s_mov_b32 s76, 0x3
    s_mov_b32 s77, 0x3
    s_and_b64 vcc, vcc, s[76:77]
    s_cbranch_scc0 Lvd_8
    s_sub_u32 s33, s33, 1
    s_cbranch_scc1 Lvd_8
    s_sleep 3
    s_branch Lvc_9
Lvs_10:
    s_movk_i32 s33, 20000
Lvc_12:
    buffer_load_dword v24, v252, s[52:55], 0 offen sc1
    s_waitcnt vmcnt(0)
    v_cmp_ne_u32 vcc, s94, v24
    s_mov_b32 s76, 0xf7
    s_mov_b32 s77, 0x7
    s_and_b64 vcc, vcc, s[76:77]
    s_cbranch_scc0 Lvd_11
    s_sub_u32 s33, s33, 1
    s_cbranch_scc1 Lvd_11
    s_sleep 3
    s_branch Lvc_12
Lvs_13:
    s_movk_i32 s33, 20000
Lvc_15:
    buffer_load_dwordx2 v[246:247], v236, s[52:55], 0 offen sc1
    s_waitcnt vmcnt(0)
    v_cmp_ne_u32 vcc, s94, v247
    s_mov_b32 s76, 0xffffffff
    s_mov_b32 s77, 0xffffff
    s_and_b64 vcc, vcc, s[76:77]
    s_cbranch_scc0 Lvd_14
    s_sub_u32 s33, s33, 1
    s_cbranch_scc1 Lvd_14
    s_sleep 3
    s_branch Lvc_15
Lvs_16:
    s_movk_i32 s33, 20000
Lvc_18:
    buffer_load_dwordx2 v[246:247], v236, s[52:55], 0 offen sc1
    s_waitcnt vmcnt(0)
    v_cmp_ne_u32 vcc, s94, v247
    s_mov_b32 s76, 0x0
    s_mov_b32 s77, 0xff000000
    s_and_b64 vcc, vcc, s[76:77]
    s_cbranch_scc0 Lvd_17
    s_sub_u32 s33, s33, 1
    s_cbranch_scc1 Lvd_17
    s_sleep 3
    s_branch Lvc_18
Lvs_22:
    s_movk_i32 s33, 20000
Lvc_24:
    buffer_load_dwordx4 v[168:171], v250, s[52:55], 0 offen sc1
    buffer_load_dwordx4 v[172:175], v21, s[52:55], 0 offen offset:0 sc1
    buffer_load_dwordx4 v[176:179], v21, s[52:55], 0 offen offset:1024 sc1
    buffer_load_dwordx4 v[180:183], v21, s[52:55], 0 offen offset:2048 sc1
    buffer_load_dwordx4 v[184:187], v21, s[52:55], 0 offen offset:3072 sc1
    s_waitcnt vmcnt(0)
    v_cndmask_b32 v187, v187, v248, s[78:79]
    v_xor_b32 v169, v248, v169
    v_bitop3_b32 v169, v169, v171, v248 bitop3:0xf6
    v_bitop3_b32 v169, v169, v175, v248 bitop3:0xf6
    v_bitop3_b32 v169, v169, v179, v248 bitop3:0xf6
    v_bitop3_b32 v169, v169, v183, v248 bitop3:0xf6
    v_bitop3_b32 v169, v169, v187, v248 bitop3:0xf6
    v_cmp_ne_u32 vcc, 0, v169
    s_nop 1
    s_cmp_lg_u64 vcc, 0
    s_cbranch_scc0 Lvd_23
    s_sub_u32 s33, s33, 1
    s_cbranch_scc1 Lvd_23
    s_sleep 4
    s_branch Lvc_24
Lsl_33:
    s_sub_u32 s33, s33, 1
    s_cbranch_scc1 Lbk_34
    s_sleep 2
    s_mov_b32 s31, 0
    buffer_load_dwordx4 v[72:75], v12, s[52:55], s31 offen sc1
    s_mov_b32 s31, 4096
    buffer_load_dwordx4 v[76:79], v12, s[52:55], s31 offen sc1
    s_mov_b32 s31, 8192
    buffer_load_dwordx4 v[80:83], v12, s[52:55], s31 offen sc1
    s_mov_b32 s31, 12288
    buffer_load_dwordx4 v[84:87], v12, s[52:55], s31 offen sc1
    s_mov_b32 s31, 16384
    buffer_load_dwordx4 v[88:91], v12, s[52:55], s31 offen sc1
    s_mov_b32 s31, 20480
    buffer_load_dwordx4 v[92:95], v12, s[52:55], s31 offen sc1
    s_mov_b32 s31, 24576
    buffer_load_dwordx4 v[96:99], v12, s[52:55], s31 offen sc1
    s_mov_b32 s31, 28672
    buffer_load_dwordx4 v[100:103], v12, s[52:55], s31 offen sc1
    s_mov_b32 s31, 32768
    buffer_load_dwordx4 v[104:107], v12, s[52:55], s31 offen sc1
    s_mov_b32 s31, 36864
    buffer_load_dwordx4 v[108:111], v12, s[52:55], s31 offen sc1
    s_mov_b32 s31, 40960
    buffer_load_dwordx4 v[112:115], v12, s[52:55], s31 offen sc1
    s_mov_b32 s31, 45056
    buffer_load_dwordx4 v[116:119], v12, s[52:55], s31 offen sc1
    s_mov_b32 s31, 49152
    buffer_load_dwordx4 v[120:123], v12, s[52:55], s31 offen sc1
    s_mov_b32 s31, 53248
    buffer_load_dwordx4 v[124:127], v12, s[52:55], s31 offen sc1
    s_mov_b32 s31, 57344
    buffer_load_dwordx4 v[128:131], v12, s[52:55], s31 offen sc1
    s_mov_b32 s31, 61440
    buffer_load_dwordx4 v[132:135], v12, s[52:55], s31 offen sc1
    s_branch Lck_32
Lsl_36:
    s_sub_u32 s33, s33, 1
    s_cbranch_scc1 Lbk_37
    s_sleep 2
    s_mov_b32 s31, 16384
    buffer_load_dwordx4 v[88:91], v12, s[52:55], s31 offen sc1
    s_mov_b32 s31, 20480
    buffer_load_dwordx4 v[92:95], v12, s[52:55], s31 offen sc1
    s_mov_b32 s31, 24576
    buffer_load_dwordx4 v[96:99], v12, s[52:55], s31 offen sc1
    s_mov_b32 s31, 28672
    buffer_load_dwordx4 v[100:103], v12, s[52:55], s31 offen sc1
    s_mov_b32 s31, 32768
    buffer_load_dwordx4 v[104:107], v12, s[52:55], s31 offen sc1
    s_mov_b32 s31, 36864
    buffer_load_dwordx4 v[108:111], v12, s[52:55], s31 offen sc1
    s_mov_b32 s31, 40960
    buffer_load_dwordx4 v[112:115], v12, s[52:55], s31 offen sc1
    s_mov_b32 s31, 45056
    buffer_load_dwordx4 v[116:119], v12, s[52:55], s31 offen sc1
    s_mov_b32 s31, 49152
    buffer_load_dwordx4 v[120:123], v12, s[52:55], s31 offen sc1
    s_mov_b32 s31, 53248
    buffer_load_dwordx4 v[124:127], v12, s[52:55], s31 offen sc1
    s_mov_b32 s31, 57344
    buffer_load_dwordx4 v[128:131], v12, s[52:55], s31 offen sc1
    s_mov_b32 s31, 61440
    buffer_load_dwordx4 v[132:135], v12, s[52:55], s31 offen sc1
    s_branch Lck_35
Lsl_39:
    s_sub_u32 s33, s33, 1
    s_cbranch_scc1 Lbk_40
    s_sleep 2
    s_mov_b32 s31, 32768
    buffer_load_dwordx4 v[104:107], v12, s[52:55], s31 offen sc1
    s_mov_b32 s31, 36864
    buffer_load_dwordx4 v[108:111], v12, s[52:55], s31 offen sc1
    s_mov_b32 s31, 40960
    buffer_load_dwordx4 v[112:115], v12, s[52:55], s31 offen sc1
    s_mov_b32 s31, 45056
    buffer_load_dwordx4 v[116:119], v12, s[52:55], s31 offen sc1
    s_mov_b32 s31, 49152
    buffer_load_dwordx4 v[120:123], v12, s[52:55], s31 offen sc1
    s_mov_b32 s31, 53248
    buffer_load_dwordx4 v[124:127], v12, s[52:55], s31 offen sc1
    s_mov_b32 s31, 57344
    buffer_load_dwordx4 v[128:131], v12, s[52:55], s31 offen sc1
    s_mov_b32 s31, 61440
    buffer_load_dwordx4 v[132:135], v12, s[52:55], s31 offen sc1
    s_branch Lck_38
Lsl_42:
    s_sub_u32 s33, s33, 1
    s_cbranch_scc1 Lbk_43
    s_sleep 2
    s_mov_b32 s31, 49152
    buffer_load_dwordx4 v[120:123], v12, s[52:55], s31 offen sc1
    s_mov_b32 s31, 53248
    buffer_load_dwordx4 v[124:127], v12, s[52:55], s31 offen sc1
    s_mov_b32 s31, 57344
    buffer_load_dwordx4 v[128:131], v12, s[52:55], s31 offen sc1
    s_mov_b32 s31, 61440
    buffer_load_dwordx4 v[132:135], v12, s[52:55], s31 offen sc1
    s_branch Lck_41
Lcode_end:
    s_endpgm
.section .rodata,"a"
.p2align 6
.amdhsa_kernel parallel_sum__linear_attn_block__mixer_channel_mlp__prompt_kernel
  .amdhsa_next_free_vgpr 256
  .amdhsa_next_free_sgpr 102
  .amdhsa_accum_offset 256
  .amdhsa_group_segment_fixed_size 0
  .amdhsa_kernarg_size 88
  .amdhsa_user_sgpr_count 2
  .amdhsa_user_sgpr_kernarg_segment_ptr 1
  .amdhsa_system_sgpr_workgroup_id_x 1
.end_amdhsa_kernel
```
